```python
import torch

def _softmax(x, axis=-1):
    return torch.softmax(x, dim=axis)
def _gelu(x):
    return torch.nn.functional.gelu(x, approximate="tanh")
def _silu(x):
    return torch.nn.functional.silu(x)
def _sigmoid(x):
    return torch.sigmoid(x)
def _layernorm(x, axis=-1, eps=1e-5):
    m = x.mean(dim=axis, keepdim=True)
    v = x.var(dim=axis, keepdim=True, unbiased=False)
    return (x - m) / torch.sqrt(v + eps)
def _scatter_add(tgt, idx, src, axis=0):
    return tgt.clone().index_add_(axis, idx, src)
def _segment_sum(src, seg, n):
    out = torch.zeros((n,) + src.shape[1:], dtype=src.dtype)
    return out.index_add_(0, seg, src)
def _pad(x, pw):
    flat = tuple(v for pair in reversed(pw) for v in pair)
    return torch.nn.functional.pad(x, flat)

kernel_name = 'parallel_sum__sliding_block_cached__dense_activation_relu__decode'

def setup_inputs():

    _w = (lambda a: (lambda t: t.to(torch.bfloat16) if t.is_floating_point() else t)(torch.as_tensor(a)))
    def _A_setup():
        B, Sq, D = 2, 1, 512
        Hq, Hkv, Sk, Dh = 32, 8, 32768, 128
        assert Hq % Hkv == 0, (Hq, Hkv)
        return {
            "x": _w((lambda *s: torch.randn(*s, dtype=torch.bfloat16) * 0.05)(B, Sq, D)),
            "k_cache": _w((lambda *s: torch.randn(*s, dtype=torch.bfloat16) * 3.2)(B, Hkv, Sk, Dh)),
            "v_cache": _w((lambda *s: torch.randn(*s, dtype=torch.bfloat16) * 1.6)(B, Hkv, Sk, Dh)),
            "wq": _w((lambda *s: torch.randn(*s, dtype=torch.bfloat16) * 3.2)(D, Hq * Dh) * (D ** -0.5)),
            "wo": _w((lambda *s: torch.randn(*s, dtype=torch.bfloat16) * 1.6)(Hq * Dh, D) * ((Hq * Dh) ** -0.5)),
        }
    _A_in = _A_setup()

    def _B_setup():
        B, S, D, Dff = 2, 1, 512, 1792
        return {
            "x": _w((lambda *s: torch.randn(*s, dtype=torch.bfloat16) * 0.05)(B, S, D)),
            "w1": _w((lambda *s: torch.randn(*s, dtype=torch.bfloat16) * 0.05)(D, Dff)),
            "w2": _w((lambda *s: torch.randn(*s, dtype=torch.bfloat16) * 0.05)(Dff, D)),
        }
    _B_in = _B_setup()

    return {
        "A_x": _A_in["x"],
        "A_k_cache": _A_in["k_cache"],
        "A_v_cache": _A_in["v_cache"],
        "A_wq": _A_in["wq"],
        "A_wo": _A_in["wo"],
        "B_x": _B_in["x"],
        "B_w1": _B_in["w1"],
        "B_w2": _B_in["w2"],
    }

def reference(A_x, A_k_cache, A_v_cache, A_wq, A_wo, B_x, B_w1, B_w2):
    def _A_ref(x, k_cache, v_cache, wq, wo):
        B, Sq, D = x.shape
        Hq, Dh = 32, 128
        Hkv, Sk = k_cache.shape[1], k_cache.shape[2]
        W = min(4096, max(256, Sk // 4))
        rep = Hq // Hkv
        q = (lambda x, *d: x.permute(*d))((x @ wq).reshape(B, Sq, Hq, Dh), 0, 2, 1, 3)
        k = (lambda x, n, axis: torch.repeat_interleave(x, n, dim=axis))(k_cache[:, :, Sk - W:, :], rep, axis=1)
        v = (lambda x, n, axis: torch.repeat_interleave(x, n, dim=axis))(v_cache[:, :, Sk - W:, :], rep, axis=1)
        scores = torch.einsum("bhqd,bhkd->bhqk", q, k) * (Dh ** -0.5)
        p = _softmax(scores, axis=-1)
        o = torch.einsum("bhqk,bhkd->bhqd", p, v)
        return (lambda x, *d: x.permute(*d))(o, 0, 2, 1, 3).reshape(B, Sq, Hq * Dh) @ wo

    def _B_ref(x, w1, w2):
        h = torch.einsum("bsd,df->bsf", x, w1)
        zero = torch.zeros_like(h)
        h = torch.maximum(h, zero)
        return torch.einsum("bsf,fd->bsd", h, w2)

    x = A_x
    xn = _layernorm(x, axis=-1)
    return x + _A_ref(xn, A_k_cache, A_v_cache, A_wq, A_wo) + _B_ref(xn, B_w1, B_w2)
```

```asm
; @launch grid=(256,1,1) block=(512,1,1) lds=136448
.amdgcn_target "amdgcn-amd-amdhsa--gfx950"
.text
.globl parallel_sum__sliding_block_cached__dense_activation_relu__decode_kernel
.p2align 8
.type parallel_sum__sliding_block_cached__dense_activation_relu__decode_kernel,@function
parallel_sum__sliding_block_cached__dense_activation_relu__decode_kernel:
    s_lshr_b32 s4, s2, 8
    s_cbranch_scc1 L_end
    v_lshrrev_b32 v2, 6, v0
    s_load_dwordx16 s[8:23], s[0:1], 0
    v_readfirstlane_b32 s3, v2
    s_load_dwordx4 s[24:27], s[0:1], 64
    s_load_dwordx2 s[28:29], s[0:1], 80
    v_and_b32 v0, 63, v0
    s_cmp_eq_u32 s3, 3
    s_cbranch_scc1 L_other
    s_cmp_eq_u32 s3, 2
    s_cbranch_scc1 L_pad1
    s_cmp_eq_u32 s3, 1
    s_cbranch_scc1 L_pad2
    s_cmp_eq_u32 s3, 6
    s_cbranch_scc1 L_pad4
    s_cmp_eq_u32 s3, 7
    s_cbranch_scc1 L_pad5
L_common0:
    s_cmp_eq_u32 s3, 4
    s_cbranch_scc0 L_common
    s_getpc_b64 s[4:5]
L_pc:
    v_lshlrev_b32 v8, 7, v0
    global_load_dword v226, v8, s[4:5]
    v_add_u32 v9, 0x2000, v8
    v_min_u32 v9, L_code_end-L_pc-4, v9
    global_load_dword v227, v9, s[4:5]
L_common:
    v_mov_b32 v3, 0
    v_and_b32 v1, 15, v0
    v_lshrrev_b32 v2, 4, v0
    s_and_b32 s30, s2, 7
    s_lshr_b32 s31, s2, 3
    s_mov_b32 s39, 0x20000
    s_mov_b32 s43, 0x20000
    v_lshlrev_b32 v14, 4, v0
    s_cmp_eq_u32 s3, 0
    s_cbranch_scc1 L_s0_pre
    s_barrier
    s_cmp_lt_u32 s3, 4
    s_cbranch_scc1 L_other3
    s_branch L_att_setup
L_s0_pre:
    s_lshr_b32 s48, s31, 3
    s_and_b32 s49, s31, 7
    s_lshl_b32 s50, s30, 3
    s_add_u32 s49, s49, s50
    s_lshl_b32 s50, s48, 20
    s_lshl_b32 s51, s49, 7
    s_add_u32 s50, s50, s51
    s_movk_i32 s57, 0x2000
    s_movk_i32 s42, 0x800
    s_mov_b32 s38, 1040512
    v_lshrrev_b32 v9, 5, v0
    v_lshlrev_b32 v9, 10, v9
    v_and_b32 v10, 31, v0
    v_lshl_add_u32 v11, v10, 3, v9
    v_lshl_add_u32 v9, v10, 2, v9
    v_lshrrev_b32 v10, 3, v1
    v_and_b32 v228, 7, v1
    v_lshl_add_u32 v228, v10, 15, v228
    s_lshl_b32 s52, s48, 8
    s_and_b32 s53, s31, 7
    s_lshl_b32 s53, s53, 7
    s_waitcnt lgkmcnt(0)
    s_mov_b64 s[40:41], s[8:9]
    s_mov_b64 s[36:37], s[14:15]
    buffer_load_dwordx4 v[24:27], v14, s[40:43], 0 offen
    buffer_load_dwordx4 v[28:31], v14, s[40:43], 0 offen offset:1024
    buffer_load_dwordx2 v[32:33], v11, s[40:43], s52 offen
    buffer_load_dword v34, v9, s[40:43], s53 offen
    s_load_dword s59, s[28:29], 0
    s_call_b64 s[60:61], F_LOADBLK
    s_barrier
    s_branch L_service
L_pad1:
    s_branch L_common0
F_LOADBLK:
    s_add_u32 s36, s36, s50
    s_addc_u32 s37, s37, 0
    s_lshl_b32 s55, s57, 4
    v_mul_u32_u24 v6, s55, v2
    v_lshl_add_u32 v6, v228, 4, v6
    buffer_load_dwordx4 v[64:67], v6, s[36:39], 0 offen nt
    s_mov_b32 s55, s57
    buffer_load_dwordx4 v[68:71], v6, s[36:39], s55 offen nt
    s_add_u32 s55, s55, s57
    buffer_load_dwordx4 v[72:75], v6, s[36:39], s55 offen nt
    s_add_u32 s55, s55, s57
    buffer_load_dwordx4 v[76:79], v6, s[36:39], s55 offen nt
    s_add_u32 s55, s55, s57
    buffer_load_dwordx4 v[80:83], v6, s[36:39], s55 offen nt
    s_add_u32 s55, s55, s57
    s_branch L_padskip2
L_pad2:
    s_branch L_common0
L_padskip2:
    buffer_load_dwordx4 v[84:87], v6, s[36:39], s55 offen nt
    s_add_u32 s55, s55, s57
    buffer_load_dwordx4 v[88:91], v6, s[36:39], s55 offen nt
    s_add_u32 s55, s55, s57
    buffer_load_dwordx4 v[92:95], v6, s[36:39], s55 offen nt
    s_add_u32 s55, s55, s57
    buffer_load_dwordx4 v[96:99], v6, s[36:39], s55 offen nt
    s_add_u32 s55, s55, s57
    buffer_load_dwordx4 v[100:103], v6, s[36:39], s55 offen nt
    s_add_u32 s55, s55, s57
    buffer_load_dwordx4 v[104:107], v6, s[36:39], s55 offen nt
    s_add_u32 s55, s55, s57
    buffer_load_dwordx4 v[108:111], v6, s[36:39], s55 offen nt
    s_add_u32 s55, s55, s57
    buffer_load_dwordx4 v[112:115], v6, s[36:39], s55 offen nt
    s_add_u32 s55, s55, s57
    buffer_load_dwordx4 v[116:119], v6, s[36:39], s55 offen nt
    s_add_u32 s55, s55, s57
    buffer_load_dwordx4 v[120:123], v6, s[36:39], s55 offen nt
    s_add_u32 s55, s55, s57
    buffer_load_dwordx4 v[124:127], v6, s[36:39], s55 offen nt
    s_setpc_b64 s[60:61]
L_other:
    v_mov_b32 v3, 0
    v_and_b32 v1, 15, v0
    v_lshrrev_b32 v2, 4, v0
    s_and_b32 s30, s2, 7
    s_lshr_b32 s31, s2, 3
    s_mov_b32 s39, 0x20000
    s_mov_b32 s43, 0x20000
    v_lshlrev_b32 v6, 2, v1
    ds_write_b32 v6, v3
    s_lshr_b32 s52, s31, 4
    s_lshl_b32 s48, s52, 26
    s_lshl_b32 s49, s30, 23
    s_add_u32 s48, s48, s49
    s_add_u32 s48, s48, 0x700000
    v_xor_b32 v8, v2, v1
    v_lshlrev_b32 v8, 4, v8
    v_lshl_add_u32 v8, v2, 8, v8
    v_xor_b32 v9, 64, v8
    v_xor_b32 v10, 0x80, v8
    v_xor_b32 v11, 64, v10
    s_mov_b32 s38, 0x100000
    s_mov_b32 s42, s38
    s_lshl_b32 s50, s30, 5
    s_add_u32 s50, s50, s31
    s_branch L_padskip4
L_pad4:
    s_branch L_common0
L_padskip4:
    s_lshl_b32 s50, s50, 12
    s_and_b32 s50, s50, 0xff000
    s_waitcnt lgkmcnt(0)
    s_add_u32 s36, s10, s48
    s_addc_u32 s37, s11, 0
    s_add_u32 s40, s12, s48
    s_addc_u32 s41, s13, 0
    s_setprio 1
    s_barrier
    s_mov_b32 s52, 4294967280
    s_mov_b32 s53, 5376
    s_mov_b32 s51, s50
L_ldk:
    s_mov_b32 m0, s53
    s_max_i32 s54, s52, 0
    v_mov_b32 v15, s54
    s_waitcnt vmcnt(19)
    buffer_load_dwordx4 v8, s[36:39], s51 offen offset:0 nt lds
    s_waitcnt vmcnt(19)
    buffer_load_dwordx4 v9, s[36:39], s51 offen offset:1024 nt lds
    s_waitcnt vmcnt(19)
    buffer_load_dwordx4 v10, s[36:39], s51 offen offset:2048 nt lds
    s_waitcnt vmcnt(19)
    ds_write_b32 v3, v15 offset:16
    buffer_load_dwordx4 v11, s[36:39], s51 offen offset:3072 nt lds
    s_add_u32 s56, s51, 4096
    s_add_u32 s51, s51, 0x10000
    s_and_b32 s56, s56, 0xf000
    s_and_b32 s51, s51, 0xf0000
    s_or_b32 s51, s51, s56
    s_add_u32 s53, s53, 0x1000
    s_add_u32 s52, s52, 4
    s_cmp_lt_u32 s53, 70912
    s_cbranch_scc1 L_ldk
    s_branch L_padskip5
L_pad5:
    s_branch L_common0
L_padskip5:
    v_lshlrev_b32 v12, 1, v2
    v_xor_b32 v12, v12, v1
    v_lshlrev_b32 v12, 4, v12
    v_lshl_add_u32 v12, v2, 8, v12
    v_xor_b32 v13, 0x80, v12
    s_mov_b32 s51, s50
L_ldv:
    s_mov_b32 m0, s53
    s_max_i32 s54, s52, 0
    v_mov_b32 v15, s54
    s_waitcnt vmcnt(19)
    buffer_load_dwordx4 v12, s[40:43], s51 offen offset:0 nt lds
    s_waitcnt vmcnt(19)
    buffer_load_dwordx4 v12, s[40:43], s51 offen offset:1024 nt lds
    s_waitcnt vmcnt(19)
    buffer_load_dwordx4 v13, s[40:43], s51 offen offset:2048 nt lds
    s_waitcnt vmcnt(19)
    ds_write_b32 v3, v15 offset:16
    buffer_load_dwordx4 v13, s[40:43], s51 offen offset:3072 nt lds
    s_add_u32 s56, s51, 4096
    s_add_u32 s51, s51, 0x10000
    s_and_b32 s56, s56, 0xf000
    s_and_b32 s51, s51, 0xf0000
    s_or_b32 s51, s51, s56
    s_add_u32 s53, s53, 0x1000
    s_add_u32 s52, s52, 4
    s_cmp_lt_u32 s53, 136448
    s_cbranch_scc1 L_ldv
    v_mov_b32 v14, 1
    ds_write_b32 v3, v14 offset:24
    s_setprio 3
    v_mov_b32 v15, 112
    s_waitcnt vmcnt(16)
    ds_write_b32 v3, v15 offset:16
    v_mov_b32 v14, 116
    s_waitcnt vmcnt(12)
    ds_write_b32 v3, v14 offset:16
    v_mov_b32 v15, 120
    s_waitcnt vmcnt(8)
    ds_write_b32 v3, v15 offset:16
    v_mov_b32 v14, 124
    s_waitcnt vmcnt(4)
    ds_write_b32 v3, v14 offset:16
    v_mov_b32 v15, 128
    s_waitcnt vmcnt(0)
    ds_write_b32 v3, v15 offset:16
    s_endpgm
L_att_setup:
    s_sub_u32 s3, s3, 4
    s_mov_b32 s34, 4194304
    s_mov_b32 s35, 0x20000
    v_mov_b32 v15, 1
    v_and_b32 v8, 3, v1
    v_mul_u32_u24 v9, 320, v8
    v_lshl_add_u32 v9, v2, 4, v9
    v_lshlrev_b32 v10, 4, v8
    s_lshl_b32 s48, s3, 2
    v_add_u32 v11, s48, v10
    s_add_u32 s50, s48, 4
    s_lshl_b32 s48, s3, 12
    s_add_u32 s48, s48, 5376
    v_add_u32 v208, 0, v2
    v_xor_b32 v208, v208, v1
    v_lshlrev_b32 v208, 4, v208
    v_lshl_add_u32 v208, v1, 8, v208
    v_add_u32 v208, s48, v208
    v_add_u32 v209, 4, v2
    v_xor_b32 v209, v209, v1
    v_lshlrev_b32 v209, 4, v209
    v_lshl_add_u32 v209, v1, 8, v209
    v_add_u32 v209, s48, v209
    v_add_u32 v210, 8, v2
    v_xor_b32 v210, v210, v1
    v_lshlrev_b32 v210, 4, v210
    v_lshl_add_u32 v210, v1, 8, v210
    v_add_u32 v210, s48, v210
    v_add_u32 v211, 12, v2
    v_xor_b32 v211, v211, v1
    v_lshlrev_b32 v211, 4, v211
    v_lshl_add_u32 v211, v1, 8, v211
    v_add_u32 v211, s48, v211
    v_mul_u32_u24 v12, 576, v8
    v_lshl_add_u32 v13, v2, 4, v12
    v_lshl_add_u32 v12, v2, 3, v12
    s_lshl_b32 s48, s3, 5
    v_add_u32 v12, s48, v12
    v_lshrrev_b32 v56, 2, v1
    v_and_b32 v57, 1, v2
    v_lshl_or_b32 v57, v57, 2, v56
    v_lshl_add_u32 v56, v2, 3, v56
    v_lshlrev_b32 v56, 8, v56
    v_lshl_add_u32 v56, v8, 3, v56
    v_add_u32 v56, 70912, v56
    s_lshl_b32 s48, s3, 1
    v_xor_b32 v212, s48, v57
    v_lshl_add_u32 v212, v212, 5, v56
    v_xor_b32 v213, s48, v57
    v_xor_b32 v213, 1, v213
    v_lshl_add_u32 v213, v213, 5, v56
    v_lshlrev_b32 v5, 9, v8
    v_lshl_add_u32 v5, v2, 4, v5
    v_and_b32 v56, 4, v1
    v_lshl_add_u32 v5, v56, 4, v5
    s_lshl_b32 s48, s3, 7
    v_add_u32 v5, s48, v5
    s_lshl_b32 s54, s30, 5
    s_add_u32 s54, s54, s31
    s_lshl_b32 s55, s54, 7
    s_add_u32 s55, s55, 458752
    s_lshl_b32 s54, s54, 11
    s_add_u32 s54, s54, 524288
    s_mov_b32 s64, 0x3db504f3
    s_mov_b32 s65, 0x3db504f3
    s_mov_b32 s66, 0x3fb8aa3b
    s_mov_b32 s44, 0
    s_mov_b32 s45, 0
    v_mov_b32 v224, 0xff
    s_waitcnt lgkmcnt(0)
    s_mov_b32 s32, s28
    s_mov_b32 s33, s29
    s_movk_i32 s67, 1000
    s_mov_b64 s[62:63], 0
    s_mov_b64 exec, 0
L_att_body:
    s_mov_b32 s58, 0
L_spin_1:
    ds_read_b32 v56, v3 offset:4
    s_waitcnt lgkmcnt(0)
    v_cmp_eq_u32 vcc, 0, v56
    s_cbranch_vccz L_spd_2
    s_sleep 2
    s_add_u32 s58, s58, 1
    s_cmp_lt_u32 s58, 2097152
    s_cbranch_scc1 L_spin_1
L_spd_2:
    ds_read_b128 v[24:27], v9 offset:576
    ds_read_b128 v[28:31], v9 offset:640
    ds_read_b128 v[32:35], v9 offset:704
    ds_read_b128 v[36:39], v9 offset:768
    ds_read_b32 v57, v3 offset:28
    s_waitcnt lgkmcnt(0)
    v_readfirstlane_b32 s45, v57
    s_nop 0
    s_and_b32 s44, s45, 15
    s_and_b32 s86, s45, 255
    s_not_b32 s48, s45
    v_mov_b32 v60, s48
    v_mov_b32 v61, s48
    v_mov_b32 v62, s48
    v_mov_b32 v63, s48
    s_and_b32 exec_lo, s62, 0x00ff00ff
    s_and_b32 exec_hi, s62, 0x00ff00ff
    s_cbranch_execz L_prew_g
    buffer_store_dwordx4 v[60:63], v5, s[32:35], s54 offen
    s_and_b32 exec_lo, s62, 0xff
    s_mov_b32 exec_hi, 0
    buffer_store_dwordx4 v[60:63], v14, s[32:35], s55 offen
L_prew_g:
    s_mov_b64 exec, s[62:63]
    s_add_u32 s51, s50, 0
    s_cmp_ge_i32 s67, s51
    s_cbranch_scc1 L_wpd_4
    s_mov_b32 s58, 0
L_wp_3:
    ds_read_b32 v59, v3 offset:16
    s_waitcnt lgkmcnt(0)
    v_readfirstlane_b32 s67, v59
    s_add_u32 s58, s58, 1
    s_cmp_ge_i32 s67, s51
    s_cbranch_scc1 L_wpd_4
    s_sleep 1
    s_cmp_lt_u32 s58, 2097152
    s_cbranch_scc1 L_wp_3
L_wpd_4:
    ds_read_b128 v[64:67], v208 offset:0
    ds_read_b128 v[68:71], v209 offset:0
    ds_read_b128 v[72:75], v210 offset:0
    ds_read_b128 v[76:79], v211 offset:0
    s_add_u32 s51, s50, 16
    s_cmp_ge_i32 s67, s51
    s_cbranch_scc1 L_wpd_6
    s_mov_b32 s58, 0
L_wp_5:
    ds_read_b32 v59, v3 offset:16
    s_waitcnt lgkmcnt(0)
    v_readfirstlane_b32 s67, v59
    s_add_u32 s58, s58, 1
    s_cmp_ge_i32 s67, s51
    s_cbranch_scc1 L_wpd_6
    s_sleep 1
    s_cmp_lt_u32 s58, 2097152
    s_cbranch_scc1 L_wp_5
L_wpd_6:
    ds_read_b128 v[80:83], v208 offset:16384
    ds_read_b128 v[84:87], v209 offset:16384
    ds_read_b128 v[88:91], v210 offset:16384
    ds_read_b128 v[92:95], v211 offset:16384
    s_waitcnt lgkmcnt(7)
    v_mfma_f32_16x16x32_bf16 v[40:43], v[64:67], v[24:27], 0
    s_waitcnt lgkmcnt(6)
    v_mfma_f32_16x16x32_bf16 v[40:43], v[68:71], v[28:31], v[40:43]
    s_waitcnt lgkmcnt(5)
    v_mfma_f32_16x16x32_bf16 v[40:43], v[72:75], v[32:35], v[40:43]
    s_waitcnt lgkmcnt(4)
    v_mfma_f32_16x16x32_bf16 v[40:43], v[76:79], v[36:39], v[40:43]
    s_add_u32 s51, s50, 32
    s_cmp_ge_i32 s67, s51
    s_cbranch_scc1 L_wpd_8
    s_mov_b32 s58, 0
L_wp_7:
    ds_read_b32 v59, v3 offset:16
    s_waitcnt lgkmcnt(0)
    v_readfirstlane_b32 s67, v59
    s_add_u32 s58, s58, 1
    s_cmp_ge_i32 s67, s51
    s_cbranch_scc1 L_wpd_8
    s_sleep 1
    s_cmp_lt_u32 s58, 2097152
    s_cbranch_scc1 L_wp_7
L_wpd_8:
    ds_read_b128 v[64:67], v208 offset:32768
    ds_read_b128 v[68:71], v209 offset:32768
    ds_read_b128 v[72:75], v210 offset:32768
    ds_read_b128 v[76:79], v211 offset:32768
    s_waitcnt lgkmcnt(7)
    v_mfma_f32_16x16x32_bf16 v[44:47], v[80:83], v[24:27], 0
    s_waitcnt lgkmcnt(6)
    v_mfma_f32_16x16x32_bf16 v[44:47], v[84:87], v[28:31], v[44:47]
    s_waitcnt lgkmcnt(5)
    v_mfma_f32_16x16x32_bf16 v[44:47], v[88:91], v[32:35], v[44:47]
    s_waitcnt lgkmcnt(4)
    v_mfma_f32_16x16x32_bf16 v[44:47], v[92:95], v[36:39], v[44:47]
    v_cvt_pk_bf16_f32 v56, v40, v41
    v_cvt_pk_bf16_f32 v57, v42, v43
    v_lshlrev_b32 v40, 16, v56
    v_and_b32 v41, 0xffff0000, v56
    v_lshlrev_b32 v42, 16, v57
    v_and_b32 v43, 0xffff0000, v57
    v_pk_mul_f32 v[40:41], v[40:41], s[64:65]
    v_pk_mul_f32 v[42:43], v[42:43], s[64:65]
    v_cvt_pk_bf16_f32 v56, v40, v41
    v_cvt_pk_bf16_f32 v57, v42, v43
    v_lshlrev_b32 v40, 16, v56
    v_and_b32 v41, 0xffff0000, v56
    v_lshlrev_b32 v42, 16, v57
    v_and_b32 v43, 0xffff0000, v57
    v_max3_f32 v58, v40, v41, v42
    v_max_f32 v58, v58, v43
    s_add_u32 s51, s50, 48
    s_cmp_ge_i32 s67, s51
    s_cbranch_scc1 L_wpd_10
    s_mov_b32 s58, 0
L_wp_9:
    ds_read_b32 v59, v3 offset:16
    s_waitcnt lgkmcnt(0)
    v_readfirstlane_b32 s67, v59
    s_add_u32 s58, s58, 1
    s_cmp_ge_i32 s67, s51
    s_cbranch_scc1 L_wpd_10
    s_cmp_lt_u32 s58, 2097152
    s_cbranch_scc1 L_wp_9
L_wpd_10:
    ds_read_b128 v[80:83], v208 offset:49152
    ds_read_b128 v[84:87], v209 offset:49152
    ds_read_b128 v[88:91], v210 offset:49152
    ds_read_b128 v[92:95], v211 offset:49152
    s_waitcnt lgkmcnt(7)
    v_mfma_f32_16x16x32_bf16 v[48:51], v[64:67], v[24:27], 0
    s_waitcnt lgkmcnt(6)
    v_mfma_f32_16x16x32_bf16 v[48:51], v[68:71], v[28:31], v[48:51]
    s_waitcnt lgkmcnt(5)
    v_mfma_f32_16x16x32_bf16 v[48:51], v[72:75], v[32:35], v[48:51]
    s_waitcnt lgkmcnt(4)
    v_mfma_f32_16x16x32_bf16 v[48:51], v[76:79], v[36:39], v[48:51]
    v_cvt_pk_bf16_f32 v56, v44, v45
    v_cvt_pk_bf16_f32 v57, v46, v47
    v_lshlrev_b32 v44, 16, v56
    v_and_b32 v45, 0xffff0000, v56
    v_lshlrev_b32 v46, 16, v57
    v_and_b32 v47, 0xffff0000, v57
    v_pk_mul_f32 v[44:45], v[44:45], s[64:65]
    v_pk_mul_f32 v[46:47], v[46:47], s[64:65]
    v_cvt_pk_bf16_f32 v56, v44, v45
    v_cvt_pk_bf16_f32 v57, v46, v47
    v_lshlrev_b32 v44, 16, v56
    v_and_b32 v45, 0xffff0000, v56
    v_lshlrev_b32 v46, 16, v57
    v_and_b32 v47, 0xffff0000, v57
    v_max3_f32 v58, v58, v44, v45
    v_max3_f32 v58, v58, v46, v47
    s_waitcnt lgkmcnt(3)
    v_mfma_f32_16x16x32_bf16 v[52:55], v[80:83], v[24:27], 0
    s_waitcnt lgkmcnt(2)
    v_mfma_f32_16x16x32_bf16 v[52:55], v[84:87], v[28:31], v[52:55]
    s_waitcnt lgkmcnt(1)
    v_mfma_f32_16x16x32_bf16 v[52:55], v[88:91], v[32:35], v[52:55]
    s_waitcnt lgkmcnt(0)
    v_mfma_f32_16x16x32_bf16 v[52:55], v[92:95], v[36:39], v[52:55]
    v_cvt_pk_bf16_f32 v56, v48, v49
    v_cvt_pk_bf16_f32 v57, v50, v51
    v_lshlrev_b32 v48, 16, v56
    v_and_b32 v49, 0xffff0000, v56
    v_lshlrev_b32 v50, 16, v57
    v_and_b32 v51, 0xffff0000, v57
    v_pk_mul_f32 v[48:49], v[48:49], s[64:65]
    v_pk_mul_f32 v[50:51], v[50:51], s[64:65]
    v_cvt_pk_bf16_f32 v56, v48, v49
    v_cvt_pk_bf16_f32 v57, v50, v51
    v_lshlrev_b32 v48, 16, v56
    v_and_b32 v49, 0xffff0000, v56
    v_lshlrev_b32 v50, 16, v57
    v_and_b32 v51, 0xffff0000, v57
    v_max3_f32 v58, v58, v48, v49
    v_max3_f32 v58, v58, v50, v51
    v_cvt_pk_bf16_f32 v56, v52, v53
    v_cvt_pk_bf16_f32 v57, v54, v55
    v_lshlrev_b32 v52, 16, v56
    v_and_b32 v53, 0xffff0000, v56
    v_lshlrev_b32 v54, 16, v57
    v_and_b32 v55, 0xffff0000, v57
    v_pk_mul_f32 v[52:53], v[52:53], s[64:65]
    v_pk_mul_f32 v[54:55], v[54:55], s[64:65]
    v_cvt_pk_bf16_f32 v56, v52, v53
    v_cvt_pk_bf16_f32 v57, v54, v55
    v_lshlrev_b32 v52, 16, v56
    v_and_b32 v53, 0xffff0000, v56
    v_lshlrev_b32 v54, 16, v57
    v_and_b32 v55, 0xffff0000, v57
    v_max3_f32 v58, v58, v52, v53
    v_max3_f32 v58, v58, v54, v55
    v_mov_b32 v59, v58
    s_nop 1
    v_permlane16_swap_b32 v59, v58
    s_nop 0
    v_max_f32 v58, v58, v59
    v_mov_b32 v59, v58
    s_nop 1
    v_permlane32_swap_b32 v59, v58
    s_nop 0
    v_max_f32 v58, v58, v59
    s_and_b32 exec_lo, s62, 15
    s_mov_b32 exec_hi, 0
    ds_write_b32 v11, v58 offset:1856
    s_and_b32 exec_lo, s62, 1
    ds_add_u32 v3, v15 offset:8
    s_mov_b64 exec, s[62:63]
    s_mov_b32 s58, 0
L_spin_11:
    ds_read_b32 v56, v3 offset:8
    s_waitcnt lgkmcnt(0)
    v_cmp_ne_u32 vcc, 4, v56
    s_cbranch_vccz L_spd_12
    s_add_u32 s58, s58, 1
    s_cmp_lt_u32 s58, 2097152
    s_cbranch_scc1 L_spin_11
L_spd_12:
    ds_read_b128 v[60:63], v10 offset:1856
    s_waitcnt lgkmcnt(0)
    v_max3_f32 v58, v60, v61, v62
    v_max_f32 v58, v58, v63
    v_sub_f32 v40, v40, v58
    v_sub_f32 v41, v41, v58
    v_sub_f32 v42, v42, v58
    v_sub_f32 v43, v43, v58
    v_sub_f32 v44, v44, v58
    v_sub_f32 v45, v45, v58
    v_sub_f32 v46, v46, v58
    v_sub_f32 v47, v47, v58
    v_sub_f32 v48, v48, v58
    v_sub_f32 v49, v49, v58
    v_sub_f32 v50, v50, v58
    v_sub_f32 v51, v51, v58
    v_sub_f32 v52, v52, v58
    v_sub_f32 v53, v53, v58
    v_sub_f32 v54, v54, v58
    v_sub_f32 v55, v55, v58
    v_mul_f32 v40, s66, v40
    v_mul_f32 v41, s66, v41
    v_mul_f32 v42, s66, v42
    v_mul_f32 v43, s66, v43
    v_mul_f32 v44, s66, v44
    v_mul_f32 v45, s66, v45
    v_mul_f32 v46, s66, v46
    v_mul_f32 v47, s66, v47
    v_mul_f32 v48, s66, v48
    v_mul_f32 v49, s66, v49
    v_mul_f32 v50, s66, v50
    v_mul_f32 v51, s66, v51
    v_mul_f32 v52, s66, v52
    v_mul_f32 v53, s66, v53
    v_mul_f32 v54, s66, v54
    v_mul_f32 v55, s66, v55
    v_exp_f32 v40, v40
    v_exp_f32 v41, v41
    v_exp_f32 v42, v42
    v_exp_f32 v43, v43
    v_exp_f32 v44, v44
    v_exp_f32 v45, v45
    v_exp_f32 v46, v46
    v_exp_f32 v47, v47
    v_exp_f32 v48, v48
    v_exp_f32 v49, v49
    v_exp_f32 v50, v50
    v_exp_f32 v51, v51
    v_exp_f32 v52, v52
    v_exp_f32 v53, v53
    v_exp_f32 v54, v54
    v_exp_f32 v55, v55
    v_pk_add_f32 v[60:61], v[40:41], v[42:43]
    v_pk_add_f32 v[60:61], v[60:61], v[44:45]
    v_pk_add_f32 v[60:61], v[60:61], v[46:47]
    v_pk_add_f32 v[60:61], v[60:61], v[48:49]
    v_pk_add_f32 v[60:61], v[60:61], v[50:51]
    v_pk_add_f32 v[60:61], v[60:61], v[52:53]
    v_pk_add_f32 v[60:61], v[60:61], v[54:55]
    v_cvt_pk_bf16_f32 v16, v40, v41
    v_cvt_pk_bf16_f32 v17, v42, v43
    v_cvt_pk_bf16_f32 v18, v44, v45
    v_cvt_pk_bf16_f32 v19, v46, v47
    v_cvt_pk_bf16_f32 v20, v48, v49
    v_cvt_pk_bf16_f32 v21, v50, v51
    v_cvt_pk_bf16_f32 v22, v52, v53
    v_cvt_pk_bf16_f32 v23, v54, v55
    v_add_f32 v60, v60, v61
    s_and_b32 exec_lo, s62, 0x000f000f
    s_and_b32 exec_hi, s62, 0x000f000f
    ds_write_b64 v12, v[16:17] offset:2624
    ds_write_b64 v12, v[18:19] offset:2752
    ds_write_b64 v12, v[20:21] offset:2880
    ds_write_b64 v12, v[22:23] offset:3008
    s_mov_b64 exec, s[62:63]
    v_mov_b32 v59, v60
    s_nop 1
    v_permlane16_swap_b32 v59, v60
    s_nop 0
    v_add_f32 v60, v60, v59
    v_mov_b32 v59, v60
    s_nop 1
    v_permlane32_swap_b32 v59, v60
    s_nop 0
    v_add_f32 v60, v60, v59
    s_and_b32 exec_lo, s62, 15
    s_mov_b32 exec_hi, 0
    ds_write_b32 v11, v60 offset:1920
    s_waitcnt vmcnt(0)
    s_and_b32 exec_lo, s62, 1
    ds_add_rtn_u32 v56, v3, v15 offset:12
    s_waitcnt lgkmcnt(0)
    v_cmp_ne_u32 vcc, 3, v56
    s_cbranch_vccnz L_att_pv
    s_and_b32 exec_lo, s62, 0xff
    ds_read_b128 v[40:43], v10 offset:1920
    v_mov_b32 v62, s45
    v_not_b32 v63, v62
    v_or_b32 v60, s44, v58
    s_waitcnt lgkmcnt(0)
    v_add_f32 v40, v40, v41
    v_add_f32 v42, v42, v43
    v_add_f32 v40, v40, v42
    v_bfi_b32 v61, 15, s44, v40
    s_cbranch_execz L_att_pv
    buffer_store_dwordx4 v[60:63], v14, s[32:35], s55 offen
    s_add_u32 s49, s55, 2097152
    buffer_store_dwordx4 v[60:63], v14, s[32:35], s49 offen sc1
L_att_pv:
    s_mov_b64 exec, s[62:63]
    s_mov_b32 s58, 0
L_spin_13:
    ds_read_b32 v56, v3 offset:12
    s_waitcnt lgkmcnt(0)
    v_cmp_ne_u32 vcc, 4, v56
    s_cbranch_vccz L_spd_14
    s_add_u32 s58, s58, 1
    s_cmp_lt_u32 s58, 2097152
    s_cbranch_scc1 L_spin_13
L_spd_14:
    ds_read_b128 v[128:131], v13 offset:2624
    ds_read_b128 v[132:135], v13 offset:2688
    ds_read_b128 v[136:139], v13 offset:2752
    ds_read_b128 v[140:143], v13 offset:2816
    ds_read_b128 v[144:147], v13 offset:2880
    ds_read_b128 v[148:151], v13 offset:2944
    ds_read_b128 v[152:155], v13 offset:3008
    ds_read_b128 v[156:159], v13 offset:3072
    s_setprio 2
    s_waitcnt lgkmcnt(0)
    s_cmp_ge_i32 s67, 72
    s_cbranch_scc1 L_wpd_16
    s_mov_b32 s58, 0
L_wp_15:
    ds_read_b32 v59, v3 offset:16
    s_waitcnt lgkmcnt(0)
    v_readfirstlane_b32 s67, v59
    s_add_u32 s58, s58, 1
    s_cmp_ge_i32 s67, 72
    s_cbranch_scc1 L_wpd_16
    s_sleep 1
    s_cmp_lt_u32 s58, 2097152
    s_cbranch_scc1 L_wp_15
L_wpd_16:
    ds_read_b64_tr_b16 v[64:65], v212 offset:0
    ds_read_b64_tr_b16 v[66:67], v212 offset:1024
    ds_read_b64_tr_b16 v[68:69], v213 offset:0
    ds_read_b64_tr_b16 v[70:71], v213 offset:1024
    s_cmp_ge_i32 s67, 80
    s_cbranch_scc1 L_wpd_18
    s_mov_b32 s58, 0
L_wp_17:
    ds_read_b32 v59, v3 offset:16
    s_waitcnt lgkmcnt(0)
    v_readfirstlane_b32 s67, v59
    s_add_u32 s58, s58, 1
    s_cmp_ge_i32 s67, 80
    s_cbranch_scc1 L_wpd_18
    s_sleep 1
    s_cmp_lt_u32 s58, 2097152
    s_cbranch_scc1 L_wp_17
L_wpd_18:
    ds_read_b64_tr_b16 v[72:73], v212 offset:8192
    ds_read_b64_tr_b16 v[74:75], v212 offset:9216
    ds_read_b64_tr_b16 v[76:77], v213 offset:8192
    ds_read_b64_tr_b16 v[78:79], v213 offset:9216
    s_waitcnt lgkmcnt(6)
    v_mfma_f32_16x16x32_bf16 v[192:195], v[64:67], v[128:131], 0
    s_waitcnt lgkmcnt(4)
    v_mfma_f32_16x16x32_bf16 v[196:199], v[68:71], v[128:131], 0
    s_cmp_ge_i32 s67, 88
    s_cbranch_scc1 L_wpd_20
    s_mov_b32 s58, 0
L_wp_19:
    ds_read_b32 v59, v3 offset:16
    s_waitcnt lgkmcnt(0)
    v_readfirstlane_b32 s67, v59
    s_add_u32 s58, s58, 1
    s_cmp_ge_i32 s67, 88
    s_cbranch_scc1 L_wpd_20
    s_sleep 1
    s_cmp_lt_u32 s58, 2097152
    s_cbranch_scc1 L_wp_19
L_wpd_20:
    ds_read_b64_tr_b16 v[64:65], v212 offset:16384
    ds_read_b64_tr_b16 v[66:67], v212 offset:17408
    ds_read_b64_tr_b16 v[68:69], v213 offset:16384
    ds_read_b64_tr_b16 v[70:71], v213 offset:17408
    s_waitcnt lgkmcnt(6)
    v_mfma_f32_16x16x32_bf16 v[192:195], v[72:75], v[132:135], v[192:195]
    s_waitcnt lgkmcnt(4)
    v_mfma_f32_16x16x32_bf16 v[196:199], v[76:79], v[132:135], v[196:199]
    s_cmp_ge_i32 s67, 96
    s_cbranch_scc1 L_wpd_22
    s_mov_b32 s58, 0
L_wp_21:
    ds_read_b32 v59, v3 offset:16
    s_waitcnt lgkmcnt(0)
    v_readfirstlane_b32 s67, v59
    s_add_u32 s58, s58, 1
    s_cmp_ge_i32 s67, 96
    s_cbranch_scc1 L_wpd_22
    s_sleep 1
    s_cmp_lt_u32 s58, 2097152
    s_cbranch_scc1 L_wp_21
L_wpd_22:
    ds_read_b64_tr_b16 v[72:73], v212 offset:24576
    ds_read_b64_tr_b16 v[74:75], v212 offset:25600
    ds_read_b64_tr_b16 v[76:77], v213 offset:24576
    ds_read_b64_tr_b16 v[78:79], v213 offset:25600
    s_waitcnt lgkmcnt(6)
    v_mfma_f32_16x16x32_bf16 v[192:195], v[64:67], v[136:139], v[192:195]
    s_waitcnt lgkmcnt(4)
    v_mfma_f32_16x16x32_bf16 v[196:199], v[68:71], v[136:139], v[196:199]
    s_cmp_ge_i32 s67, 104
    s_cbranch_scc1 L_wpd_24
    s_mov_b32 s58, 0
L_wp_23:
    ds_read_b32 v59, v3 offset:16
    s_waitcnt lgkmcnt(0)
    v_readfirstlane_b32 s67, v59
    s_add_u32 s58, s58, 1
    s_cmp_ge_i32 s67, 104
    s_cbranch_scc1 L_wpd_24
    s_sleep 1
    s_cmp_lt_u32 s58, 2097152
    s_cbranch_scc1 L_wp_23
L_wpd_24:
    ds_read_b64_tr_b16 v[64:65], v212 offset:32768
    ds_read_b64_tr_b16 v[66:67], v212 offset:33792
    ds_read_b64_tr_b16 v[68:69], v213 offset:32768
    ds_read_b64_tr_b16 v[70:71], v213 offset:33792
    s_waitcnt lgkmcnt(6)
    v_mfma_f32_16x16x32_bf16 v[192:195], v[72:75], v[140:143], v[192:195]
    s_waitcnt lgkmcnt(4)
    v_mfma_f32_16x16x32_bf16 v[196:199], v[76:79], v[140:143], v[196:199]
    s_cmp_ge_i32 s67, 112
    s_cbranch_scc1 L_wpd_26
    s_mov_b32 s58, 0
L_wp_25:
    ds_read_b32 v59, v3 offset:16
    s_waitcnt lgkmcnt(0)
    v_readfirstlane_b32 s67, v59
    s_add_u32 s58, s58, 1
    s_cmp_ge_i32 s67, 112
    s_cbranch_scc1 L_wpd_26
    s_sleep 1
    s_cmp_lt_u32 s58, 2097152
    s_cbranch_scc1 L_wp_25
L_wpd_26:
    ds_read_b64_tr_b16 v[72:73], v212 offset:40960
    ds_read_b64_tr_b16 v[74:75], v212 offset:41984
    ds_read_b64_tr_b16 v[76:77], v213 offset:40960
    ds_read_b64_tr_b16 v[78:79], v213 offset:41984
    s_waitcnt lgkmcnt(6)
    v_mfma_f32_16x16x32_bf16 v[192:195], v[64:67], v[144:147], v[192:195]
    s_waitcnt lgkmcnt(4)
    v_mfma_f32_16x16x32_bf16 v[196:199], v[68:71], v[144:147], v[196:199]
    s_cmp_ge_i32 s67, 120
    s_cbranch_scc1 L_wpd_28
    s_mov_b32 s58, 0
L_wp_27:
    ds_read_b32 v59, v3 offset:16
    s_waitcnt lgkmcnt(0)
    v_readfirstlane_b32 s67, v59
    s_add_u32 s58, s58, 1
    s_cmp_ge_i32 s67, 120
    s_cbranch_scc1 L_wpd_28
    s_cmp_lt_u32 s58, 2097152
    s_cbranch_scc1 L_wp_27
L_wpd_28:
    ds_read_b64_tr_b16 v[64:65], v212 offset:49152
    ds_read_b64_tr_b16 v[66:67], v212 offset:50176
    ds_read_b64_tr_b16 v[68:69], v213 offset:49152
    ds_read_b64_tr_b16 v[70:71], v213 offset:50176
    s_waitcnt lgkmcnt(6)
    v_mfma_f32_16x16x32_bf16 v[192:195], v[72:75], v[148:151], v[192:195]
    s_waitcnt lgkmcnt(4)
    v_mfma_f32_16x16x32_bf16 v[196:199], v[76:79], v[148:151], v[196:199]
    s_cmp_ge_i32 s67, 128
    s_cbranch_scc1 L_wpd_30
    s_mov_b32 s58, 0
L_wp_29:
    ds_read_b32 v59, v3 offset:16
    s_waitcnt lgkmcnt(0)
    v_readfirstlane_b32 s67, v59
    s_add_u32 s58, s58, 1
    s_cmp_ge_i32 s67, 128
    s_cbranch_scc1 L_wpd_30
    s_cmp_lt_u32 s58, 2097152
    s_cbranch_scc1 L_wp_29
L_wpd_30:
    ds_read_b64_tr_b16 v[72:73], v212 offset:57344
    ds_read_b64_tr_b16 v[74:75], v212 offset:58368
    ds_read_b64_tr_b16 v[76:77], v213 offset:57344
    ds_read_b64_tr_b16 v[78:79], v213 offset:58368
    s_waitcnt lgkmcnt(6)
    v_mfma_f32_16x16x32_bf16 v[192:195], v[64:67], v[152:155], v[192:195]
    s_waitcnt lgkmcnt(4)
    v_mfma_f32_16x16x32_bf16 v[196:199], v[68:71], v[152:155], v[196:199]
    s_waitcnt lgkmcnt(2)
    v_mfma_f32_16x16x32_bf16 v[192:195], v[72:75], v[156:159], v[192:195]
    s_waitcnt lgkmcnt(0)
    v_mfma_f32_16x16x32_bf16 v[196:199], v[76:79], v[156:159], v[196:199]
    s_and_b32 exec_lo, s62, 0x000f000f
    s_and_b32 exec_hi, s62, 0x000f000f
    s_nop 4
    v_bfi_b32 v56, v224, s86, v192
    v_mov_b32 v57, v193
    v_mov_b32 v58, v194
    v_mov_b32 v59, v195
    s_and_b32 exec_lo, s62, 0x00f000f0
    s_and_b32 exec_hi, s62, 0x00f000f0
    v_bfi_b32 v56, v224, s86, v196
    v_mov_b32 v57, v197
    v_mov_b32 v58, v198
    v_mov_b32 v59, v199
    s_and_b32 exec_lo, s62, 0x00ff00ff
    s_and_b32 exec_hi, s62, 0x00ff00ff
    s_cbranch_execz L_att_live
    buffer_store_dwordx4 v[56:59], v5, s[32:35], s54 offen
    s_add_u32 s49, s54, 2097152
    buffer_store_dwordx4 v[56:59], v5, s[32:35], s49 offen sc1
    s_mov_b64 exec, 1
    ds_add_u32 v3, v15 offset:36
    s_endpgm
L_att_live:
    s_mov_b32 s67, 0
    s_setprio 0
    s_mov_b64 s[62:63], -1
    s_mov_b64 exec, -1
    s_branch L_att_body
F_T0:
    s_waitcnt vmcnt(14)
    v_perm_b32 v128, v68, v64, s46
    v_perm_b32 v132, v68, v64, s47
    v_perm_b32 v136, v69, v65, s46
    v_perm_b32 v140, v69, v65, s47
    v_perm_b32 v144, v70, v66, s46
    v_perm_b32 v148, v70, v66, s47
    v_perm_b32 v152, v71, v67, s46
    v_perm_b32 v156, v71, v67, s47
    s_waitcnt vmcnt(12)
    v_perm_b32 v129, v76, v72, s46
    v_perm_b32 v133, v76, v72, s47
    v_perm_b32 v137, v77, v73, s46
    v_perm_b32 v141, v77, v73, s47
    v_perm_b32 v145, v78, v74, s46
    v_perm_b32 v149, v78, v74, s47
    v_perm_b32 v153, v79, v75, s46
    v_perm_b32 v157, v79, v75, s47
    s_waitcnt vmcnt(10)
    v_perm_b32 v130, v84, v80, s46
    v_perm_b32 v134, v84, v80, s47
    v_perm_b32 v138, v85, v81, s46
    v_perm_b32 v142, v85, v81, s47
    v_perm_b32 v146, v86, v82, s46
    v_perm_b32 v150, v86, v82, s47
    v_perm_b32 v154, v87, v83, s46
    v_perm_b32 v158, v87, v83, s47
    s_waitcnt vmcnt(8)
    v_perm_b32 v131, v92, v88, s46
    v_perm_b32 v135, v92, v88, s47
    v_perm_b32 v139, v93, v89, s46
    v_perm_b32 v143, v93, v89, s47
    v_perm_b32 v147, v94, v90, s46
    v_perm_b32 v151, v94, v90, s47
    v_perm_b32 v155, v95, v91, s46
    v_perm_b32 v159, v95, v91, s47
    s_setpc_b64 s[60:61]
F_T1:
    s_waitcnt vmcnt(6)
    v_perm_b32 v160, v100, v96, s46
    v_perm_b32 v164, v100, v96, s47
    v_perm_b32 v168, v101, v97, s46
    v_perm_b32 v172, v101, v97, s47
    v_perm_b32 v176, v102, v98, s46
    v_perm_b32 v180, v102, v98, s47
    v_perm_b32 v184, v103, v99, s46
    v_perm_b32 v188, v103, v99, s47
    s_waitcnt vmcnt(4)
    v_perm_b32 v161, v108, v104, s46
    v_perm_b32 v165, v108, v104, s47
    v_perm_b32 v169, v109, v105, s46
    v_perm_b32 v173, v109, v105, s47
    v_perm_b32 v177, v110, v106, s46
    v_perm_b32 v181, v110, v106, s47
    v_perm_b32 v185, v111, v107, s46
    v_perm_b32 v189, v111, v107, s47
    s_waitcnt vmcnt(2)
    v_perm_b32 v162, v116, v112, s46
    v_perm_b32 v166, v116, v112, s47
    v_perm_b32 v170, v117, v113, s46
    v_perm_b32 v174, v117, v113, s47
    v_perm_b32 v178, v118, v114, s46
    v_perm_b32 v182, v118, v114, s47
    v_perm_b32 v186, v119, v115, s46
    v_perm_b32 v190, v119, v115, s47
    s_waitcnt vmcnt(0)
    v_perm_b32 v163, v124, v120, s46
    v_perm_b32 v167, v124, v120, s47
    v_perm_b32 v171, v125, v121, s46
    v_perm_b32 v175, v125, v121, s47
    v_perm_b32 v179, v126, v122, s46
    v_perm_b32 v183, v126, v122, s47
    v_perm_b32 v187, v127, v123, s46
    v_perm_b32 v191, v127, v123, s47
    s_setpc_b64 s[60:61]
F_MMA:
    ds_read_b128 v[16:19], v4
    ds_read_b128 v[20:23], v4 offset:16
    s_waitcnt lgkmcnt(0)
    v_mfma_f32_16x16x32_bf16 v[192:195], v[16:19], v[128:131], 0
    v_mfma_f32_16x16x32_bf16 v[196:199], v[16:19], v[132:135], 0
    v_mfma_f32_16x16x32_bf16 v[200:203], v[16:19], v[136:139], 0
    v_mfma_f32_16x16x32_bf16 v[204:207], v[16:19], v[140:143], 0
    v_mfma_f32_16x16x32_bf16 v[208:211], v[16:19], v[144:147], 0
    v_mfma_f32_16x16x32_bf16 v[212:215], v[16:19], v[148:151], 0
    v_mfma_f32_16x16x32_bf16 v[216:219], v[16:19], v[152:155], 0
    v_mfma_f32_16x16x32_bf16 v[220:223], v[16:19], v[156:159], 0
    s_cmp_eq_u32 s57, 0x2000
    v_mfma_f32_16x16x32_bf16 v[192:195], v[20:23], v[160:163], v[192:195]
    v_mfma_f32_16x16x32_bf16 v[196:199], v[20:23], v[164:167], v[196:199]
    v_mfma_f32_16x16x32_bf16 v[200:203], v[20:23], v[168:171], v[200:203]
    v_mfma_f32_16x16x32_bf16 v[204:207], v[20:23], v[172:175], v[204:207]
    v_mfma_f32_16x16x32_bf16 v[208:211], v[20:23], v[176:179], v[208:211]
    v_mfma_f32_16x16x32_bf16 v[212:215], v[20:23], v[180:183], v[212:215]
    v_mfma_f32_16x16x32_bf16 v[216:219], v[20:23], v[184:187], v[216:219]
    v_mfma_f32_16x16x32_bf16 v[220:223], v[20:23], v[188:191], v[220:223]
    s_cbranch_scc1 L_mma_q
L_mma_pub:
    s_and_b32 exec_lo, s62, 0xffff
    s_mov_b32 exec_hi, 0
    s_nop 1
    v_bfi_b32 v56, v224, s87, v192
    v_bfi_b32 v57, v225, s87, v196
    v_bfi_b32 v58, v225, s87, v200
    v_bfi_b32 v59, v225, s87, v204
    s_mov_b32 exec_lo, 0
    s_and_b32 exec_hi, s62, 0xffff
    v_bfi_b32 v56, v224, s87, v193
    v_bfi_b32 v57, v225, s87, v197
    v_bfi_b32 v58, v225, s87, v201
    v_bfi_b32 v59, v225, s87, v205
    s_and_b32 exec_lo, s62, 0xffff0000
    s_mov_b32 exec_hi, 0
    v_bfi_b32 v56, v224, s87, v208
    v_bfi_b32 v57, v225, s87, v212
    v_bfi_b32 v58, v225, s87, v216
    v_bfi_b32 v59, v225, s87, v220
    s_mov_b32 exec_lo, 0
    s_and_b32 exec_hi, s62, 0xffff0000
    v_bfi_b32 v56, v224, s87, v209
    v_bfi_b32 v57, v225, s87, v213
    v_bfi_b32 v58, v225, s87, v217
    v_bfi_b32 v59, v225, s87, v221
    s_and_b64 exec, s[62:63], s[90:91]
    s_cbranch_execz L_mma_ret
    buffer_store_dwordx4 v[56:59], v5, s[32:35], s56 offen sc1
L_mma_ret:
    s_nop 1
    s_setpc_b64 s[60:61]
L_mma_q:
    v_add_f32_dpp v192, v194, v192 row_ror:8 row_mask:0xf bank_mask:0xf
    v_add_f32_dpp v193, v195, v193 row_ror:8 row_mask:0xf bank_mask:0xf
    v_add_f32_dpp v196, v198, v196 row_ror:8 row_mask:0xf bank_mask:0xf
    v_add_f32_dpp v197, v199, v197 row_ror:8 row_mask:0xf bank_mask:0xf
    v_add_f32_dpp v200, v202, v200 row_ror:8 row_mask:0xf bank_mask:0xf
    v_add_f32_dpp v201, v203, v201 row_ror:8 row_mask:0xf bank_mask:0xf
    v_add_f32_dpp v204, v206, v204 row_ror:8 row_mask:0xf bank_mask:0xf
    v_add_f32_dpp v205, v207, v205 row_ror:8 row_mask:0xf bank_mask:0xf
    v_add_f32_dpp v208, v210, v208 row_ror:8 row_mask:0xf bank_mask:0xf
    v_add_f32_dpp v209, v211, v209 row_ror:8 row_mask:0xf bank_mask:0xf
    v_add_f32_dpp v212, v214, v212 row_ror:8 row_mask:0xf bank_mask:0xf
    v_add_f32_dpp v213, v215, v213 row_ror:8 row_mask:0xf bank_mask:0xf
    v_add_f32_dpp v216, v218, v216 row_ror:8 row_mask:0xf bank_mask:0xf
    v_add_f32_dpp v217, v219, v217 row_ror:8 row_mask:0xf bank_mask:0xf
    v_add_f32_dpp v220, v222, v220 row_ror:8 row_mask:0xf bank_mask:0xf
    v_add_f32_dpp v221, v223, v221 row_ror:8 row_mask:0xf bank_mask:0xf
    s_branch L_mma_pub
L_other3:
    s_waitcnt lgkmcnt(0)
    s_cmp_eq_u32 s3, 1
    s_cbranch_scc0 L_service
    s_cmp_eq_u32 s30, 7
    s_cbranch_scc1 L_service
    s_lshl_b32 s48, s30, 1
    s_lshr_b32 s49, s31, 4
    s_add_u32 s48, s48, s49
    s_and_b32 s49, s31, 7
    s_mul_i32 s50, s49, 229376
    s_lshl_b32 s51, s48, 8
    s_add_u32 s50, s50, s51
    s_bfe_u32 s51, s31, 0x10002
    s_lshl_b32 s52, s48, 1
    s_add_u32 s52, s52, s51
    s_and_b32 s53, s31, 3
    s_lshl_b32 s54, s52, 16
    s_lshl_b32 s55, s53, 8
    s_add_u32 s54, s54, s55
    s_bitcmp1_b32 s31, 3
    s_cselect_b32 s50, s54, s50
    s_mov_b32 s57, 3584
    s_cselect_b32 s57, 0x400, s57
    s_cselect_b32 s36, s22, s20
    s_cselect_b32 s37, s23, s21
    s_mul_i32 s38, s57, 63
    s_addk_i32 s38, 0x100
    v_mov_b32 v228, v1
    s_call_b64 s[60:61], F_LOADBLK
L_service:
    s_setprio 3
    v_lshrrev_b32 v8, 1, v2
    v_lshlrev_b32 v5, 9, v8
    v_lshl_add_u32 v5, v1, 5, v5
    v_and_b32 v8, 1, v2
    v_lshl_add_u32 v5, v8, 4, v5
    v_and_b32 v8, 1, v1
    v_lshlrev_b32 v4, 7, v8
    v_lshl_add_u32 v4, v2, 5, v4
    v_mov_b32 v15, 1
    v_mov_b32 v7, 0
    v_mov_b32 v12, 0
    v_mov_b32 v224, 15
    v_mov_b32 v225, 15
    s_mov_b32 s66, 0x3fb8aa3b
    s_mov_b64 s[62:63], -1
    s_mov_b64 s[90:91], -1
    s_mov_b32 s46, 0x05040100
    s_mov_b32 s47, 0x07060302
    s_mov_b32 s32, s28
    s_mov_b32 s33, s29
    s_mov_b32 s34, 4194304
    s_mov_b32 s35, 0x20000
    s_cmp_eq_u32 s3, 2
    s_cbranch_scc1 L_so
    s_cmp_eq_u32 s3, 1
    s_cbranch_scc1 L_s1
    s_lshl_b32 s51, s49, 2
    s_add_u32 s51, s51, s48
    s_lshl_b32 s51, s51, 9
    s_add_u32 s56, s51, 2162688
    s_mov_b32 s90, 0x00ff00ff
    s_mov_b32 s91, 0x00ff00ff
    v_lshrrev_b32 v8, 1, v2
    v_lshlrev_b32 v8, 8, v8
    v_sub_u32 v5, v5, v8
    v_and_b32 v8, 1, v1
    v_lshlrev_b32 v4, 8, v8
    v_and_b32 v8, 2, v1
    v_lshl_add_u32 v4, v8, 6, v4
    v_lshl_add_u32 v4, v2, 5, v4
L_s0_body:
    s_waitcnt vmcnt(18)
    v_lshlrev_b32 v40, 16, v24
    v_and_b32 v41, 0xffff0000, v24
    v_lshlrev_b32 v42, 16, v25
    v_and_b32 v43, 0xffff0000, v25
    v_lshlrev_b32 v44, 16, v26
    v_and_b32 v45, 0xffff0000, v26
    v_lshlrev_b32 v46, 16, v27
    v_and_b32 v47, 0xffff0000, v27
    v_lshlrev_b32 v48, 16, v28
    v_and_b32 v49, 0xffff0000, v28
    v_lshlrev_b32 v50, 16, v29
    v_and_b32 v51, 0xffff0000, v29
    v_lshlrev_b32 v52, 16, v30
    v_and_b32 v53, 0xffff0000, v30
    v_lshlrev_b32 v54, 16, v31
    v_and_b32 v55, 0xffff0000, v31
    v_pk_add_f32 v[56:57], v[40:41], v[42:43]
    v_pk_add_f32 v[58:59], v[48:49], v[50:51]
    v_pk_add_f32 v[56:57], v[56:57], v[44:45]
    v_pk_add_f32 v[58:59], v[58:59], v[52:53]
    v_pk_add_f32 v[56:57], v[56:57], v[46:47]
    v_pk_add_f32 v[58:59], v[58:59], v[54:55]
    v_add_f32 v56, v56, v57
    v_add_f32 v58, v58, v59
    s_nop 0
    v_add_f32_dpp v56, v56, v56 row_ror:8 row_mask:0xf bank_mask:0xf
    v_add_f32_dpp v58, v58, v58 row_ror:8 row_mask:0xf bank_mask:0xf
    s_nop 0
    v_add_f32_dpp v56, v56, v56 row_ror:4 row_mask:0xf bank_mask:0xf
    v_add_f32_dpp v58, v58, v58 row_ror:4 row_mask:0xf bank_mask:0xf
    s_nop 0
    v_add_f32_dpp v56, v56, v56 row_ror:2 row_mask:0xf bank_mask:0xf
    v_add_f32_dpp v58, v58, v58 row_ror:2 row_mask:0xf bank_mask:0xf
    s_nop 0
    v_add_f32_dpp v56, v56, v56 row_ror:1 row_mask:0xf bank_mask:0xf
    v_add_f32_dpp v58, v58, v58 row_ror:1 row_mask:0xf bank_mask:0xf
    v_mov_b32 v57, v56
    v_mov_b32 v59, v58
    s_nop 0
    v_permlane16_swap_b32 v57, v56
    v_permlane16_swap_b32 v59, v58
    v_add_f32 v56, v56, v57
    v_add_f32 v58, v58, v59
    v_mov_b32 v57, v56
    v_mov_b32 v59, v58
    s_nop 0
    v_permlane32_swap_b32 v57, v56
    v_permlane32_swap_b32 v59, v58
    v_add_f32 v56, v56, v57
    v_add_f32 v58, v58, v59
    v_mul_f32 v56, 0x3b000000, v56
    v_mul_f32 v58, 0x3b000000, v58
    v_pk_add_f32 v[40:41], v[40:41], v[56:57] op_sel_hi:[1,0] neg_lo:[0,1] neg_hi:[0,1]
    v_pk_add_f32 v[42:43], v[42:43], v[56:57] op_sel_hi:[1,0] neg_lo:[0,1] neg_hi:[0,1]
    v_pk_add_f32 v[44:45], v[44:45], v[56:57] op_sel_hi:[1,0] neg_lo:[0,1] neg_hi:[0,1]
    v_pk_add_f32 v[46:47], v[46:47], v[56:57] op_sel_hi:[1,0] neg_lo:[0,1] neg_hi:[0,1]
    v_pk_add_f32 v[48:49], v[48:49], v[58:59] op_sel_hi:[1,0] neg_lo:[0,1] neg_hi:[0,1]
    v_pk_add_f32 v[50:51], v[50:51], v[58:59] op_sel_hi:[1,0] neg_lo:[0,1] neg_hi:[0,1]
    v_pk_add_f32 v[52:53], v[52:53], v[58:59] op_sel_hi:[1,0] neg_lo:[0,1] neg_hi:[0,1]
    v_pk_add_f32 v[54:55], v[54:55], v[58:59] op_sel_hi:[1,0] neg_lo:[0,1] neg_hi:[0,1]
    v_pk_mul_f32 v[60:61], v[40:41], v[40:41]
    v_pk_mul_f32 v[62:63], v[48:49], v[48:49]
    v_pk_fma_f32 v[60:61], v[42:43], v[42:43], v[60:61]
    v_pk_fma_f32 v[62:63], v[50:51], v[50:51], v[62:63]
    v_pk_fma_f32 v[60:61], v[44:45], v[44:45], v[60:61]
    v_pk_fma_f32 v[62:63], v[52:53], v[52:53], v[62:63]
    v_pk_fma_f32 v[60:61], v[46:47], v[46:47], v[60:61]
    v_pk_fma_f32 v[62:63], v[54:55], v[54:55], v[62:63]
    v_add_f32 v60, v60, v61
    v_add_f32 v62, v62, v63
    s_nop 0
    v_add_f32_dpp v60, v60, v60 row_ror:8 row_mask:0xf bank_mask:0xf
    v_add_f32_dpp v62, v62, v62 row_ror:8 row_mask:0xf bank_mask:0xf
    s_nop 0
    v_add_f32_dpp v60, v60, v60 row_ror:4 row_mask:0xf bank_mask:0xf
    v_add_f32_dpp v62, v62, v62 row_ror:4 row_mask:0xf bank_mask:0xf
    s_nop 0
    v_add_f32_dpp v60, v60, v60 row_ror:2 row_mask:0xf bank_mask:0xf
    v_add_f32_dpp v62, v62, v62 row_ror:2 row_mask:0xf bank_mask:0xf
    s_nop 0
    v_add_f32_dpp v60, v60, v60 row_ror:1 row_mask:0xf bank_mask:0xf
    v_add_f32_dpp v62, v62, v62 row_ror:1 row_mask:0xf bank_mask:0xf
    v_mov_b32 v61, v60
    v_mov_b32 v63, v62
    s_nop 0
    v_permlane16_swap_b32 v61, v60
    v_permlane16_swap_b32 v63, v62
    v_add_f32 v60, v60, v61
    v_add_f32 v62, v62, v63
    v_mov_b32 v61, v60
    v_mov_b32 v63, v62
    s_nop 0
    v_permlane32_swap_b32 v61, v60
    v_permlane32_swap_b32 v63, v62
    v_add_f32 v60, v60, v61
    v_add_f32 v62, v62, v63
    v_cmp_lt_u32 vcc, 31, v0
    v_mul_f32 v60, 0x3b000000, v60
    v_mul_f32 v62, 0x3b000000, v62
    v_cndmask_b32 v56, v56, v58, vcc
    v_cndmask_b32 v60, v60, v62, vcc
    v_cvt_pk_bf16_f32 v40, v56, v60
    v_lshlrev_b32 v56, 16, v40
    v_and_b32 v60, 0xffff0000, v40
    v_add_f32 v60, 0x3727c5ac, v60
    v_cvt_pk_bf16_f32 v60, v60, v60
    v_lshlrev_b32 v60, 16, v60
    v_sqrt_f32 v60, v60
    s_nop 0
    v_cvt_pk_bf16_f32 v60, v60, v60
    v_lshlrev_b32 v60, 16, v60
    v_rcp_f32 v62, v60
    s_waitcnt vmcnt(16)
    v_lshlrev_b32 v40, 16, v32
    v_and_b32 v41, 0xffff0000, v32
    v_lshlrev_b32 v42, 16, v33
    v_and_b32 v43, 0xffff0000, v33
    v_lshlrev_b32 v44, 16, v34
    v_and_b32 v45, 0xffff0000, v34
    v_sub_f32 v40, v40, v56
    v_sub_f32 v41, v41, v56
    v_sub_f32 v42, v42, v56
    v_sub_f32 v43, v43, v56
    v_sub_f32 v44, v44, v56
    v_sub_f32 v45, v45, v56
    v_cvt_pk_bf16_f32 v32, v40, v41
    v_cvt_pk_bf16_f32 v33, v42, v43
    v_cvt_pk_bf16_f32 v34, v44, v45
    v_lshlrev_b32 v40, 16, v32
    v_and_b32 v41, 0xffff0000, v32
    v_lshlrev_b32 v42, 16, v33
    v_and_b32 v43, 0xffff0000, v33
    v_lshlrev_b32 v44, 16, v34
    v_and_b32 v45, 0xffff0000, v34
    v_mul_f32 v128, v40, v62
    v_mul_f32 v129, v41, v62
    v_mul_f32 v130, v42, v62
    v_mul_f32 v131, v43, v62
    v_mul_f32 v132, v44, v62
    v_mul_f32 v133, v45, v62
    v_fma_f32 v136, -v128, v60, v40
    v_fma_f32 v137, -v129, v60, v41
    v_fma_f32 v138, -v130, v60, v42
    v_fma_f32 v139, -v131, v60, v43
    v_fma_f32 v140, -v132, v60, v44
    v_fma_f32 v141, -v133, v60, v45
    v_fma_f32 v128, v136, v62, v128
    v_fma_f32 v129, v137, v62, v129
    v_fma_f32 v130, v138, v62, v130
    v_fma_f32 v131, v139, v62, v131
    v_fma_f32 v132, v140, v62, v132
    v_fma_f32 v133, v141, v62, v133
    v_cvt_pk_bf16_f32 v32, v128, v129
    v_cvt_pk_bf16_f32 v33, v130, v131
    v_cvt_pk_bf16_f32 v34, v132, v133
    v_lshlrev_b32 v8, 2, v0
    v_lshlrev_b32 v9, 3, v0
    ds_write_b64 v9, v[32:33] offset:64
    ds_write_b32 v8, v34 offset:4928
    s_waitcnt lgkmcnt(0)
    s_add_u32 s45, s59, 1
    s_and_b32 s44, s45, 15
    s_mov_b32 s87, s44
    v_mov_b32 v8, s45
    ds_write_b32 v3, v8 offset:28
    ds_write_b32 v3, v15 offset:0
    v_add_u32 v4, 64, v4
    s_call_b64 s[60:61], F_T0
    s_call_b64 s[60:61], F_T1
    s_call_b64 s[60:61], F_MMA
    s_cbranch_execz L_qpub_g
    s_sub_u32 s49, s56, 2097152
    buffer_store_dwordx4 v[56:59], v5, s[32:35], s49 offen
L_qpub_g:
    s_mov_b64 exec, s[62:63]
    v_lshlrev_b32 v6, 11, v2
    v_lshl_add_u32 v6, v1, 4, v6
    v_lshrrev_b32 v8, 1, v2
    v_mul_u32_u24 v10, 320, v8
    v_and_b32 v8, 1, v2
    v_lshl_add_u32 v10, v8, 7, v10
    v_lshl_add_u32 v10, v1, 3, v10
    s_lshl_b32 s48, s30, 14
    s_lshr_b32 s49, s31, 4
    s_lshl_b32 s49, s49, 8
    s_add_u32 s48, s48, s49
    s_add_u32 s50, s48, 65536
    s_add_u32 s51, s50, 8192
    s_mov_b32 s58, 0
L_spin_31:
    ds_read_b32 v56, v3 offset:16
    s_waitcnt lgkmcnt(0)
    v_cmp_gt_u32 vcc, 36, v56
    s_cbranch_vccz L_spd_32
    s_sleep 2
    s_add_u32 s58, s58, 1
    s_cmp_lt_u32 s58, 2097152
    s_cbranch_scc1 L_spin_31
L_spd_32:
    s_mov_b32 s58, 0
L_qpoll:
    s_cbranch_execz L_qpoll_g
    buffer_load_dwordx4 v[64:67], v6, s[32:35], s50 offen offset:0 sc1
    buffer_load_dwordx4 v[68:71], v6, s[32:35], s50 offen offset:512 sc1
    buffer_load_dwordx4 v[72:75], v6, s[32:35], s50 offen offset:1024 sc1
    buffer_load_dwordx4 v[76:79], v6, s[32:35], s50 offen offset:1536 sc1
    buffer_load_dwordx4 v[96:99], v6, s[32:35], s51 offen offset:0 sc1
    buffer_load_dwordx4 v[100:103], v6, s[32:35], s51 offen offset:512 sc1
    buffer_load_dwordx4 v[104:107], v6, s[32:35], s51 offen offset:1024 sc1
    buffer_load_dwordx4 v[108:111], v6, s[32:35], s51 offen offset:1536 sc1
L_qpoll_g:
    s_waitcnt vmcnt(7)
    v_xor_b32 v64, s44, v64
    v_xor_b32 v65, s44, v65
    v_xor_b32 v66, s44, v66
    v_xor_b32 v67, s44, v67
    v_or3_b32 v11, v64, v65, v66
    v_or_b32 v11, v11, v67
    s_waitcnt vmcnt(6)
    v_xor_b32 v68, s44, v68
    v_xor_b32 v69, s44, v69
    v_xor_b32 v70, s44, v70
    v_xor_b32 v71, s44, v71
    v_or3_b32 v11, v11, v68, v69
    v_or3_b32 v11, v11, v70, v71
    v_pk_add_f32 v[64:65], v[64:65], v[68:69]
    v_pk_add_f32 v[66:67], v[66:67], v[70:71]
    s_waitcnt vmcnt(5)
    v_xor_b32 v72, s44, v72
    v_xor_b32 v73, s44, v73
    v_xor_b32 v74, s44, v74
    v_xor_b32 v75, s44, v75
    v_or3_b32 v11, v11, v72, v73
    v_or3_b32 v11, v11, v74, v75
    v_pk_add_f32 v[64:65], v[64:65], v[72:73]
    v_pk_add_f32 v[66:67], v[66:67], v[74:75]
    s_waitcnt vmcnt(4)
    v_xor_b32 v76, s44, v76
    v_xor_b32 v77, s44, v77
    v_xor_b32 v78, s44, v78
    v_xor_b32 v79, s44, v79
    v_or3_b32 v11, v11, v76, v77
    v_or3_b32 v11, v11, v78, v79
    v_pk_add_f32 v[64:65], v[64:65], v[76:77]
    v_pk_add_f32 v[66:67], v[66:67], v[78:79]
    s_waitcnt vmcnt(3)
    v_xor_b32 v96, s44, v96
    v_xor_b32 v97, s44, v97
    v_xor_b32 v98, s44, v98
    v_xor_b32 v99, s44, v99
    v_or3_b32 v11, v11, v96, v97
    v_or3_b32 v11, v11, v98, v99
    s_waitcnt vmcnt(2)
    v_xor_b32 v100, s44, v100
    v_xor_b32 v101, s44, v101
    v_xor_b32 v102, s44, v102
    v_xor_b32 v103, s44, v103
    v_or3_b32 v11, v11, v100, v101
    v_or3_b32 v11, v11, v102, v103
    v_pk_add_f32 v[96:97], v[96:97], v[100:101]
    v_pk_add_f32 v[98:99], v[98:99], v[102:103]
    s_waitcnt vmcnt(1)
    v_xor_b32 v104, s44, v104
    v_xor_b32 v105, s44, v105
    v_xor_b32 v106, s44, v106
    v_xor_b32 v107, s44, v107
    v_or3_b32 v11, v11, v104, v105
    v_or3_b32 v11, v11, v106, v107
    v_pk_add_f32 v[96:97], v[96:97], v[104:105]
    v_pk_add_f32 v[98:99], v[98:99], v[106:107]
    s_waitcnt vmcnt(0)
    v_xor_b32 v108, s44, v108
    v_xor_b32 v109, s44, v109
    v_xor_b32 v110, s44, v110
    v_xor_b32 v111, s44, v111
    v_or3_b32 v11, v11, v108, v109
    v_or3_b32 v11, v11, v110, v111
    v_pk_add_f32 v[96:97], v[96:97], v[108:109]
    v_pk_add_f32 v[98:99], v[98:99], v[110:111]
    v_and_b32 v11, 15, v11
    v_cmp_ne_u32 vcc, 0, v11
    s_cbranch_vccz L_qdone
    s_add_u32 s58, s58, 1
    s_bitset0_b32 s50, 21
    s_bitset0_b32 s51, 21
    s_cmp_lt_u32 s58, 2
    s_cbranch_scc1 L_fl_33
    s_bitcmp1_b32 s58, 0
    s_cbranch_scc1 L_fl_33
    s_bitset1_b32 s50, 21
    s_bitset1_b32 s51, 21
L_fl_33:
    s_cmp_lt_u32 s58, 2097152
    s_cbranch_scc1 L_qpoll
L_qdone:
    v_cvt_pk_bf16_f32 v64, v64, v65
    v_cvt_pk_bf16_f32 v65, v66, v67
    ds_write_b64 v10, v[64:65] offset:576
    v_cvt_pk_bf16_f32 v96, v96, v97
    v_cvt_pk_bf16_f32 v97, v98, v99
    ds_write_b64 v10, v[96:97] offset:1216
    ds_write_b32 v3, v15 offset:4
    s_cmp_lt_u32 s58, 2
    s_cselect_b32 s89, 0, 16
    v_mov_b32 v8, s89
    ds_write_b32 v3, v8 offset:40
    v_and_b32 v8, 31, v0
    v_lshlrev_b32 v12, 7, v8
    v_lshlrev_b32 v13, 2, v8
    s_lshl_b32 s54, s30, 12
    s_lshr_b32 s55, s31, 3
    s_lshl_b32 s55, s55, 4
    s_add_u32 s54, s54, s55
    s_add_u32 s54, s54, 458752
    s_not_b32 s55, s45
    s_mov_b32 s58, 0
L_spin_34:
    ds_read_b32 v56, v3 offset:16
    s_waitcnt lgkmcnt(0)
    v_cmp_gt_u32 vcc, 96, v56
    s_cbranch_vccz L_spd_35
    s_sleep 2
    s_add_u32 s58, s58, 1
    s_cmp_lt_u32 s58, 2097152
    s_cbranch_scc1 L_spin_34
L_spd_35:
    s_add_u32 s58, s89, 1
L_mlpoll:
    s_cbranch_execz L_mlpoll_g
    buffer_load_dwordx4 v[40:43], v12, s[32:35], s54 offen sc1
L_mlpoll_g:
    s_waitcnt vmcnt(0)
    v_xor_b32 v40, s44, v40
    v_xor_b32 v41, s44, v41
    v_xor_b32 v42, s45, v42
    v_xor_b32 v43, s55, v43
    v_or_b32 v11, v40, v41
    v_and_b32 v11, 15, v11
    v_or3_b32 v11, v11, v42, v43
    v_cmp_ne_u32 vcc, 0, v11
    s_cbranch_vccz L_mldone
    s_add_u32 s58, s58, 1
    s_bitset0_b32 s54, 21
    s_cmp_lt_u32 s58, 8
    s_cbranch_scc1 L_fl_36
    s_bitcmp1_b32 s58, 0
    s_cbranch_scc1 L_fl_36
    s_bitset1_b32 s54, 21
L_fl_36:
    s_sleep 2
    s_cmp_lt_u32 s58, 2097152
    s_cbranch_scc1 L_mlpoll
L_mldone:
    v_mov_b32 v42, v40
    s_nop 1
    v_max_f32_dpp v42, v42, v42 row_ror:8 row_mask:0xf bank_mask:0xf
    s_nop 1
    v_max_f32_dpp v42, v42, v42 row_ror:4 row_mask:0xf bank_mask:0xf
    s_nop 1
    v_max_f32_dpp v42, v42, v42 row_ror:2 row_mask:0xf bank_mask:0xf
    s_nop 1
    v_max_f32_dpp v42, v42, v42 row_ror:1 row_mask:0xf bank_mask:0xf
    v_sub_f32 v40, v40, v42
    v_mul_f32 v40, s66, v40
    v_exp_f32 v40, v40
    s_nop 0
    v_mul_f32 v41, v40, v41
    s_nop 1
    v_add_f32_dpp v41, v41, v41 row_ror:8 row_mask:0xf bank_mask:0xf
    s_nop 1
    v_add_f32_dpp v41, v41, v41 row_ror:4 row_mask:0xf bank_mask:0xf
    s_nop 1
    v_add_f32_dpp v41, v41, v41 row_ror:2 row_mask:0xf bank_mask:0xf
    s_nop 1
    v_add_f32_dpp v41, v41, v41 row_ror:1 row_mask:0xf bank_mask:0xf
    v_rcp_f32 v41, v41
    s_nop 0
    v_mul_f32 v40, v40, v41
    ds_write_b32 v13, v40 offset:1984
    ds_write_b32 v3, v15 offset:32
    s_cbranch_execz L_so_dry2
    s_endpgm
L_so:
    s_lshr_b32 s48, s31, 2
    s_and_b32 s49, s31, 3
    s_lshl_b32 s67, s30, 3
    s_add_u32 s67, s67, s48
    s_lshl_b32 s68, s67, 16
    s_lshl_b32 s52, s49, 8
    s_add_u32 s68, s68, s52
    s_lshl_b32 s52, s49, 16
    s_lshl_b32 s53, s67, 10
    s_add_u32 s52, s52, s53
    s_add_u32 s69, s52, 1048576
    s_lshl_b32 s67, s48, 8
    s_lshr_b32 s55, s31, 4
    s_lshl_b32 s55, s55, 26
    s_lshl_b32 s49, s30, 23
    s_add_u32 s55, s55, s49
    s_add_u32 s55, s55, 0x700000
    s_add_u32 s40, s12, s55
    s_addc_u32 s41, s13, 0
    s_mov_b32 s42, 0x10000
    s_add_u32 s36, s16, s68
    s_addc_u32 s37, s17, 0
    s_mov_b32 s38, 256
    s_mov_b64 exec, 1
    buffer_load_dword v58, v3, s[40:43], 0 offen nt
    buffer_load_dword v59, v3, s[36:39], 0 offen nt
    s_mov_b32 s49, 2097152
    buffer_load_dword v60, v3, s[32:35], s49 offen
    s_mov_b64 exec, -1
    v_and_b32 v8, 1, v2
    v_lshlrev_b32 v9, 4, v8
    v_lshrrev_b32 v10, 1, v2
    v_lshl_add_u32 v9, v10, 3, v9
    v_lshlrev_b32 v7, 11, v9
    v_lshl_add_u32 v7, v1, 4, v7
    v_lshlrev_b32 v9, 2, v9
    v_lshlrev_b32 v10, 7, v8
    v_lshl_add_u32 v10, v1, 3, v10
    v_lshrrev_b32 v13, 1, v2
    v_lshl_add_u32 v10, v13, 2, v10
    v_mov_b32 v224, 0xff
    v_mov_b32 v225, 0
    v_mov_b32 v6, 0
    s_mov_b32 s50, 0
    s_mov_b32 s51, 0
    s_mov_b32 s52, 0
    s_mov_b32 s53, 0
    s_mov_b32 s54, 0
    s_mov_b32 s55, 0
    s_mov_b32 s56, 0
    s_mov_b32 s59, 0
    s_mov_b32 s86, 0
    s_movk_i32 s57, 0x2000
    s_setprio 0
    s_mov_b64 s[62:63], 0
    s_mov_b64 exec, 0
    s_branch L_s0_body
L_so_dry2:
    s_branch L_so_body
L_so_live:
    s_mov_b64 s[62:63], -1
    s_mov_b64 exec, -1
    s_setprio 3
    v_add_u32 v4, 2112, v4
    s_mov_b32 s56, s69
    s_mov_b32 s36, s16
    s_mov_b32 s37, s17
    s_mov_b32 s57, 1024
    s_mov_b32 s38, 64768
    v_mov_b32 v228, v1
    s_mov_b32 s50, s68
    s_lshl_b32 s4, s30, 16
    s_add_u32 s4, s4, s67
    s_add_u32 s4, s4, 524288
    s_mov_b32 s58, 0
L_spin_37:
    ds_read_b32 v56, v3 offset:0
    s_waitcnt lgkmcnt(0)
    v_cmp_eq_u32 vcc, 0, v56
    s_cbranch_vccz L_spd_38
    s_sleep 2
    s_add_u32 s58, s58, 1
    s_cmp_lt_u32 s58, 2097152
    s_cbranch_scc1 L_spin_37
L_spd_38:
    ds_read_b32 v57, v3 offset:28
    s_waitcnt lgkmcnt(0)
    v_readfirstlane_b32 s45, v57
    s_nop 0
    s_and_b32 s44, s45, 15
    s_and_b32 s86, s45, 255
    s_mov_b32 s87, s86
    s_mov_b32 s58, 0
L_spin_39:
    ds_read_b32 v56, v3 offset:24
    s_waitcnt lgkmcnt(0)
    v_cmp_eq_u32 vcc, 0, v56
    s_cbranch_vccz L_spd_40
    s_sleep 1
    s_add_u32 s58, s58, 1
    s_cmp_lt_u32 s58, 2097152
    s_cbranch_scc1 L_spin_39
L_spd_40:
    s_call_b64 s[60:61], F_LOADBLK
    s_mov_b32 s50, s4
    s_add_u32 s51, s50, 4096
    s_add_u32 s52, s50, 8192
    s_add_u32 s53, s50, 12288
    s_call_b64 s[60:61], F_T0
L_so_body:
    s_mov_b32 s58, 0
L_spin_41:
    ds_read_b32 v56, v3 offset:36
    s_waitcnt lgkmcnt(0)
    v_cmp_ne_u32 vcc, 4, v56
    s_cbranch_vccz L_spd_42
    s_add_u32 s58, s58, 1
    s_cmp_lt_u32 s58, 2097152
    s_cbranch_scc1 L_spin_41
L_spd_42:
    s_cbranch_execz L_ml_g
    buffer_load_dwordx4 v[64:67], v7, s[32:35], s50 offen offset:0 sc1
    buffer_load_dwordx4 v[68:71], v7, s[32:35], s50 offen offset:2048 sc1
    buffer_load_dwordx4 v[72:75], v7, s[32:35], s51 offen offset:0 sc1
    buffer_load_dwordx4 v[76:79], v7, s[32:35], s51 offen offset:2048 sc1
    buffer_load_dwordx4 v[80:83], v7, s[32:35], s52 offen offset:0 sc1
    buffer_load_dwordx4 v[84:87], v7, s[32:35], s52 offen offset:2048 sc1
    buffer_load_dwordx4 v[88:91], v7, s[32:35], s53 offen offset:0 sc1
    buffer_load_dwordx4 v[92:95], v7, s[32:35], s53 offen offset:2048 sc1
L_ml_g:
    s_mov_b32 s58, 0
L_spin_43:
    ds_read_b32 v56, v3 offset:32
    s_waitcnt lgkmcnt(0)
    v_cmp_eq_u32 vcc, 0, v56
    s_cbranch_vccz L_spd_44
    s_add_u32 s58, s58, 1
    s_cmp_lt_u32 s58, 2097152
    s_cbranch_scc1 L_spin_43
L_spd_44:
    ds_read_b128 v[24:27], v9 offset:1984
    ds_read_b128 v[28:31], v9 offset:2000
    ds_read_b32 v63, v3 offset:40
    s_waitcnt vmcnt(14)
    v_perm_b32 v160, v100, v96, s46
    v_perm_b32 v164, v100, v96, s47
    v_perm_b32 v168, v101, v97, s46
    v_perm_b32 v172, v101, v97, s47
    v_perm_b32 v176, v102, v98, s46
    v_perm_b32 v180, v102, v98, s47
    v_perm_b32 v184, v103, v99, s46
    v_perm_b32 v188, v103, v99, s47
    s_waitcnt vmcnt(12)
    v_perm_b32 v161, v108, v104, s46
    v_perm_b32 v165, v108, v104, s47
    v_perm_b32 v169, v109, v105, s46
    v_perm_b32 v173, v109, v105, s47
    v_perm_b32 v177, v110, v106, s46
    v_perm_b32 v181, v110, v106, s47
    v_perm_b32 v185, v111, v107, s46
    v_perm_b32 v189, v111, v107, s47
    s_waitcnt vmcnt(10)
    v_perm_b32 v162, v116, v112, s46
    v_perm_b32 v166, v116, v112, s47
    v_perm_b32 v170, v117, v113, s46
    v_perm_b32 v174, v117, v113, s47
    v_perm_b32 v178, v118, v114, s46
    v_perm_b32 v182, v118, v114, s47
    v_perm_b32 v186, v119, v115, s46
    v_perm_b32 v190, v119, v115, s47
    s_waitcnt vmcnt(8)
    v_perm_b32 v163, v124, v120, s46
    v_perm_b32 v167, v124, v120, s47
    v_perm_b32 v171, v125, v121, s46
    v_perm_b32 v175, v125, v121, s47
    v_perm_b32 v179, v126, v122, s46
    v_perm_b32 v183, v126, v122, s47
    v_perm_b32 v187, v127, v123, s46
    v_perm_b32 v191, v127, v123, s47
    s_waitcnt lgkmcnt(0)
    v_readfirstlane_b32 s58, v63
    s_nop 0
    s_or_b32 s58, s58, 1
L_ochk:
    s_waitcnt vmcnt(7)
    v_xor_b32 v64, s86, v64
    v_pk_mul_f32 v[32:33], v[64:65], v[24:25] op_sel_hi:[1,0]
    v_pk_mul_f32 v[34:35], v[66:67], v[24:25] op_sel_hi:[1,0]
    s_waitcnt vmcnt(6)
    v_xor_b32 v68, s86, v68
    v_or_b32 v11, v64, v68
    v_pk_fma_f32 v[32:33], v[68:69], v[24:25], v[32:33] op_sel:[0,1,0] op_sel_hi:[1,1,1]
    v_pk_fma_f32 v[34:35], v[70:71], v[24:25], v[34:35] op_sel:[0,1,0] op_sel_hi:[1,1,1]
    s_waitcnt vmcnt(5)
    v_xor_b32 v72, s86, v72
    v_pk_fma_f32 v[32:33], v[72:73], v[26:27], v[32:33] op_sel_hi:[1,0,1]
    v_pk_fma_f32 v[34:35], v[74:75], v[26:27], v[34:35] op_sel_hi:[1,0,1]
    s_waitcnt vmcnt(4)
    v_xor_b32 v76, s86, v76
    v_or3_b32 v11, v11, v72, v76
    v_pk_fma_f32 v[32:33], v[76:77], v[26:27], v[32:33] op_sel:[0,1,0] op_sel_hi:[1,1,1]
    v_pk_fma_f32 v[34:35], v[78:79], v[26:27], v[34:35] op_sel:[0,1,0] op_sel_hi:[1,1,1]
    s_waitcnt vmcnt(3)
    v_xor_b32 v80, s86, v80
    v_pk_fma_f32 v[32:33], v[80:81], v[28:29], v[32:33] op_sel_hi:[1,0,1]
    v_pk_fma_f32 v[34:35], v[82:83], v[28:29], v[34:35] op_sel_hi:[1,0,1]
    s_waitcnt vmcnt(2)
    v_xor_b32 v84, s86, v84
    v_or3_b32 v11, v11, v80, v84
    v_pk_fma_f32 v[32:33], v[84:85], v[28:29], v[32:33] op_sel:[0,1,0] op_sel_hi:[1,1,1]
    v_pk_fma_f32 v[34:35], v[86:87], v[28:29], v[34:35] op_sel:[0,1,0] op_sel_hi:[1,1,1]
    s_waitcnt vmcnt(1)
    v_xor_b32 v88, s86, v88
    v_pk_fma_f32 v[32:33], v[88:89], v[30:31], v[32:33] op_sel_hi:[1,0,1]
    v_pk_fma_f32 v[34:35], v[90:91], v[30:31], v[34:35] op_sel_hi:[1,0,1]
    s_waitcnt vmcnt(0)
    v_xor_b32 v92, s86, v92
    v_or3_b32 v11, v11, v88, v92
    v_pk_fma_f32 v[32:33], v[92:93], v[30:31], v[32:33] op_sel:[0,1,0] op_sel_hi:[1,1,1]
    v_pk_fma_f32 v[34:35], v[94:95], v[30:31], v[34:35] op_sel:[0,1,0] op_sel_hi:[1,1,1]
    v_and_b32 v11, 0xff, v11
    v_cmp_ne_u32 vcc, 0, v11
    s_cbranch_vccz L_odone
    s_add_u32 s58, s58, 1
    s_bitset0_b32 s50, 21
    s_bitset0_b32 s51, 21
    s_bitset0_b32 s52, 21
    s_bitset0_b32 s53, 21
    s_cmp_lt_u32 s58, 16
    s_cbranch_scc1 L_fl_45
    s_bitcmp1_b32 s58, 0
    s_cbranch_scc1 L_fl_45
    s_bitset1_b32 s50, 21
    s_bitset1_b32 s51, 21
    s_bitset1_b32 s52, 21
    s_bitset1_b32 s53, 21
L_fl_45:
    buffer_load_dwordx4 v[64:67], v7, s[32:35], s50 offen offset:0 sc1
    buffer_load_dwordx4 v[68:71], v7, s[32:35], s50 offen offset:2048 sc1
    buffer_load_dwordx4 v[72:75], v7, s[32:35], s51 offen offset:0 sc1
    buffer_load_dwordx4 v[76:79], v7, s[32:35], s51 offen offset:2048 sc1
    buffer_load_dwordx4 v[80:83], v7, s[32:35], s52 offen offset:0 sc1
    buffer_load_dwordx4 v[84:87], v7, s[32:35], s52 offen offset:2048 sc1
    buffer_load_dwordx4 v[88:91], v7, s[32:35], s53 offen offset:0 sc1
    buffer_load_dwordx4 v[92:95], v7, s[32:35], s53 offen offset:2048 sc1
    s_cmp_lt_u32 s58, 2097152
    s_cbranch_scc1 L_ochk
L_odone:
    v_permlane32_swap_b32 v32, v34
    v_permlane32_swap_b32 v33, v35
    v_add_f32 v32, v32, v34
    v_add_f32 v33, v33, v35
    v_cvt_pk_bf16_f32 v32, v32, v33
    ds_write_b32 v10, v32 offset:2112
    s_cbranch_execz L_so_live
    s_call_b64 s[60:61], F_MMA
    ds_write_b32 v3, v15 offset:20
    s_endpgm
L_s1:
    s_cmp_eq_u32 s30, 7
    s_cbranch_scc1 L_red
    s_bitcmp1_b32 s31, 3
    s_cbranch_scc1 L_w2
    s_lshl_b32 s51, s48, 3
    s_add_u32 s51, s51, s49
    s_lshl_b32 s51, s51, 10
    s_add_u32 s56, s51, 327680
    v_add_u32 v4, 4928, v4
    s_call_b64 s[60:61], F_T0
    s_call_b64 s[60:61], F_T1
    s_mov_b32 s58, 0
L_spin_46:
    ds_read_b32 v56, v3 offset:0
    s_waitcnt lgkmcnt(0)
    v_cmp_eq_u32 vcc, 0, v56
    s_cbranch_vccz L_spd_47
    s_sleep 1
    s_add_u32 s58, s58, 1
    s_cmp_lt_u32 s58, 2097152
    s_cbranch_scc1 L_spin_46
L_spd_47:
    ds_read_b32 v57, v3 offset:28
    s_waitcnt lgkmcnt(0)
    v_readfirstlane_b32 s45, v57
    s_nop 0
    s_and_b32 s44, s45, 15
    s_and_b32 s86, s45, 255
    s_mov_b32 s87, s44
    s_call_b64 s[60:61], F_MMA
    s_endpgm
L_w2:
    s_lshl_b32 s53, s53, 15
    s_lshl_b32 s54, s52, 10
    s_add_u32 s53, s53, s54
    s_add_u32 s56, s53, 1310720
    s_lshl_b32 s53, s48, 13
    s_lshl_b32 s54, s51, 8
    s_add_u32 s53, s53, s54
    s_add_u32 s55, s53, 327680
    v_lshrrev_b32 v8, 1, v2
    v_lshlrev_b32 v7, 12, v8
    v_and_b32 v8, 1, v2
    v_lshl_add_u32 v7, v8, 9, v7
    v_lshl_add_u32 v7, v1, 4, v7
    v_lshlrev_b32 v10, 7, v8
    v_lshl_add_u32 v10, v1, 3, v10
    v_add_u32 v4, 2368, v4
    s_call_b64 s[60:61], F_T0
    s_call_b64 s[60:61], F_T1
    s_mov_b32 s58, 0
L_spin_48:
    ds_read_b32 v56, v3 offset:0
    s_waitcnt lgkmcnt(0)
    v_cmp_eq_u32 vcc, 0, v56
    s_cbranch_vccz L_spd_49
    s_sleep 1
    s_add_u32 s58, s58, 1
    s_cmp_lt_u32 s58, 2097152
    s_cbranch_scc1 L_spin_48
L_spd_49:
    ds_read_b32 v57, v3 offset:28
    s_waitcnt lgkmcnt(0)
    v_readfirstlane_b32 s45, v57
    s_nop 0
    s_and_b32 s44, s45, 15
    s_and_b32 s86, s45, 255
    s_mov_b32 s87, s86
    v_mov_b32 v224, 0xff
    v_mov_b32 v225, 0
    s_mov_b32 s58, 0
L_spin_50:
    ds_read_b32 v56, v3 offset:16
    s_waitcnt lgkmcnt(0)
    v_cmp_gt_u32 vcc, 64, v56
    s_cbranch_vccz L_spd_51
    s_sleep 4
    s_add_u32 s58, s58, 1
    s_cmp_lt_u32 s58, 2097152
    s_cbranch_scc1 L_spin_50
L_spd_51:
    s_mov_b32 s58, 0
L_hpoll:
    buffer_load_dwordx4 v[64:67], v7, s[32:35], s55 offen offset:0 sc1
    buffer_load_dwordx4 v[68:71], v7, s[32:35], s55 offen offset:1024 sc1
    buffer_load_dwordx4 v[72:75], v7, s[32:35], s55 offen offset:2048 sc1
    buffer_load_dwordx4 v[76:79], v7, s[32:35], s55 offen offset:3072 sc1
    s_waitcnt vmcnt(3)
    v_xor_b32 v64, s44, v64
    v_xor_b32 v65, s44, v65
    v_xor_b32 v66, s44, v66
    v_xor_b32 v67, s44, v67
    v_or3_b32 v11, v64, v65, v66
    v_or_b32 v11, v11, v67
    s_waitcnt vmcnt(2)
    v_xor_b32 v68, s44, v68
    v_xor_b32 v69, s44, v69
    v_xor_b32 v70, s44, v70
    v_xor_b32 v71, s44, v71
    v_or3_b32 v11, v11, v68, v69
    v_or3_b32 v11, v11, v70, v71
    v_pk_add_f32 v[64:65], v[64:65], v[68:69]
    v_pk_add_f32 v[66:67], v[66:67], v[70:71]
    s_waitcnt vmcnt(1)
    v_xor_b32 v72, s44, v72
    v_xor_b32 v73, s44, v73
    v_xor_b32 v74, s44, v74
    v_xor_b32 v75, s44, v75
    v_or3_b32 v11, v11, v72, v73
    v_or3_b32 v11, v11, v74, v75
    v_pk_add_f32 v[64:65], v[64:65], v[72:73]
    v_pk_add_f32 v[66:67], v[66:67], v[74:75]
    s_waitcnt vmcnt(0)
    v_xor_b32 v76, s44, v76
    v_xor_b32 v77, s44, v77
    v_xor_b32 v78, s44, v78
    v_xor_b32 v79, s44, v79
    v_or3_b32 v11, v11, v76, v77
    v_or3_b32 v11, v11, v78, v79
    v_pk_add_f32 v[64:65], v[64:65], v[76:77]
    v_pk_add_f32 v[66:67], v[66:67], v[78:79]
    v_and_b32 v11, 15, v11
    v_cmp_ne_u32 vcc, 0, v11
    s_cbranch_vccz L_hdone
    s_sleep 4
    s_add_u32 s58, s58, 1
    s_cmp_lt_u32 s58, 2097152
    s_cbranch_scc1 L_hpoll
L_hdone:
    v_mov_b32 v68, v64
    v_mov_b32 v69, v65
    v_mov_b32 v70, v66
    v_mov_b32 v71, v67
    v_permlane32_swap_b32 v68, v64
    v_permlane32_swap_b32 v69, v65
    v_permlane32_swap_b32 v70, v66
    v_permlane32_swap_b32 v71, v67
    v_add_f32 v64, v64, v68
    v_add_f32 v65, v65, v69
    v_add_f32 v66, v66, v70
    v_add_f32 v67, v67, v71
    v_max_f32 v64, 0, v64
    v_max_f32 v65, 0, v65
    v_max_f32 v66, 0, v66
    v_max_f32 v67, 0, v67
    v_cvt_pk_bf16_f32 v64, v64, v65
    v_cvt_pk_bf16_f32 v65, v66, v67
    ds_write_b64 v10, v[64:65] offset:2368
    s_call_b64 s[60:61], F_MMA
    s_endpgm
L_red:
    s_mov_b32 s88, s31
    s_lshr_b32 s48, s88, 4
    s_and_b32 s49, s88, 15
    s_lshr_b32 s50, s49, 2
    s_and_b32 s51, s49, 3
    s_lshl_b32 s52, s48, 9
    s_lshl_b32 s53, s51, 7
    s_add_u32 s52, s52, s53
    s_lshl_b32 s53, s50, 16
    s_add_u32 s54, s52, s53
    s_add_u32 s54, s54, 1048576
    s_lshl_b32 s53, s50, 15
    s_add_u32 s55, s52, s53
    s_add_u32 s55, s55, 1310720
    s_lshl_b32 s52, s48, 10
    s_lshl_b32 s53, s49, 6
    s_add_u32 s56, s52, s53
    v_and_b32 v8, 7, v0
    v_lshlrev_b32 v9, 3, v8
    v_lshl_add_u32 v9, v2, 1, v9
    v_lshrrev_b32 v10, 3, v0
    v_lshlrev_b32 v7, 10, v10
    v_lshl_add_u32 v7, v8, 4, v7
    s_mov_b32 s38, 2048
    s_mov_b32 s42, 2048
    s_mov_b32 s36, s8
    s_mov_b32 s37, s9
    s_mov_b32 s40, s24
    s_mov_b32 s41, s25
    buffer_load_ushort v24, v9, s[36:39], s56 offen
    buffer_load_ushort v26, v9, s[40:43], s56 offen
    v_lshlrev_b32 v8, 10, v0
    buffer_load_dword v64, v8, s[32:35], s54 offen
    s_mov_b32 exec_hi, 0
    buffer_load_dword v65, v8, s[32:35], s55 offen
    s_mov_b32 exec_hi, -1
    v_cmp_gt_u32 s[64:65], 4, v10
    s_waitcnt vmcnt(0)
    v_lshlrev_b32 v28, 16, v24
    s_mov_b32 s44, 0
    s_mov_b32 s86, 0
    s_setprio 0
    s_mov_b64 s[62:63], 0
    s_mov_b64 exec, 0
    s_branch L_red_body
L_red_live:
    s_mov_b64 s[62:63], -1
    s_mov_b64 exec, -1
    s_setprio 3
    s_mov_b32 s58, 0
L_spin_52:
    ds_read_b32 v56, v3 offset:24
    s_waitcnt lgkmcnt(0)
    v_cmp_eq_u32 vcc, 0, v56
    s_cbranch_vccz L_spd_53
    s_sleep 2
    s_add_u32 s58, s58, 1
    s_cmp_lt_u32 s58, 2097152
    s_cbranch_scc1 L_spin_52
L_spd_53:
    s_mov_b32 s58, 0
L_spin_54:
    ds_read_b32 v56, v3 offset:0
    s_waitcnt lgkmcnt(0)
    v_cmp_eq_u32 vcc, 0, v56
    s_cbranch_vccz L_spd_55
    s_sleep 2
    s_add_u32 s58, s58, 1
    s_cmp_lt_u32 s58, 2097152
    s_cbranch_scc1 L_spin_54
L_spd_55:
    ds_read_b32 v57, v3 offset:28
    s_waitcnt lgkmcnt(0)
    v_readfirstlane_b32 s45, v57
    s_nop 0
    s_and_b32 s44, s45, 15
    s_and_b32 s86, s45, 255
    s_mov_b32 s58, 0
L_bpoll:
    s_cbranch_execz L_bpoll_g
    s_mov_b32 s48, s55
    buffer_load_dwordx4 v[64:67], v7, s[32:35], s48 offen sc1
    s_add_u32 s48, s48, 8192
    buffer_load_dwordx4 v[68:71], v7, s[32:35], s48 offen sc1
    s_add_u32 s48, s48, 8192
    buffer_load_dwordx4 v[72:75], v7, s[32:35], s48 offen sc1
    s_add_u32 s48, s48, 8192
    buffer_load_dwordx4 v[76:79], v7, s[32:35], s48 offen sc1
L_bpoll_g:
    s_waitcnt vmcnt(3)
    v_xor_b32 v64, s86, v64
    s_waitcnt vmcnt(2)
    v_xor_b32 v68, s86, v68
    v_or_b32 v11, v64, v68
    v_pk_add_f32 v[40:41], v[64:65], v[68:69]
    v_pk_add_f32 v[42:43], v[66:67], v[70:71]
    s_waitcnt vmcnt(1)
    v_xor_b32 v72, s86, v72
    v_pk_add_f32 v[40:41], v[40:41], v[72:73]
    v_pk_add_f32 v[42:43], v[42:43], v[74:75]
    s_waitcnt vmcnt(0)
    v_xor_b32 v76, s86, v76
    v_cndmask_b32 v76, 0, v76, s[64:65]
    v_cndmask_b32 v77, 0, v77, s[64:65]
    v_cndmask_b32 v78, 0, v78, s[64:65]
    v_cndmask_b32 v79, 0, v79, s[64:65]
    v_or3_b32 v11, v11, v72, v76
    v_pk_add_f32 v[40:41], v[40:41], v[76:77]
    v_pk_add_f32 v[42:43], v[42:43], v[78:79]
    v_and_b32 v11, 0xff, v11
    v_cmp_ne_u32 vcc, 0, v11
    s_cbranch_vccz L_bdone
    s_sleep 2
    s_add_u32 s58, s58, 1
    s_cmp_lt_u32 s58, 2097152
    s_cbranch_scc1 L_bpoll
L_bdone:
    v_permlane16_swap_b32 v40, v41
    v_permlane16_swap_b32 v42, v43
    v_add_f32 v40, v40, v41
    v_add_f32 v42, v42, v43
    s_nop 1
    v_permlane32_swap_b32 v40, v42
    v_add_f32 v40, v40, v42
    s_nop 1
    v_add_f32_dpp v40, v40, v40 row_ror:8 row_mask:0xf bank_mask:0xf
    v_cvt_pk_bf16_f32 v40, v40, v40
    v_lshlrev_b32 v32, 16, v40
    s_mov_b32 s58, 0
L_spin_56:
    ds_read_b32 v56, v3 offset:20
    s_waitcnt lgkmcnt(0)
    v_cmp_eq_u32 vcc, 0, v56
    s_cbranch_vccz L_spd_57
    s_sleep 1
    s_add_u32 s58, s58, 1
    s_cmp_lt_u32 s58, 2097152
    s_cbranch_scc1 L_spin_56
L_spd_57:
L_red_body:
    s_mov_b32 s58, 0
    s_cbranch_execz L_apoll_g0
    s_mov_b32 s48, s54
    buffer_load_dwordx4 v[64:67], v7, s[32:35], s48 offen sc1
    s_add_u32 s48, s48, 8192
    buffer_load_dwordx4 v[68:71], v7, s[32:35], s48 offen sc1
    s_add_u32 s48, s48, 8192
    buffer_load_dwordx4 v[72:75], v7, s[32:35], s48 offen sc1
    s_add_u32 s48, s48, 8192
    buffer_load_dwordx4 v[76:79], v7, s[32:35], s48 offen sc1
    s_add_u32 s48, s48, 8192
    buffer_load_dwordx4 v[80:83], v7, s[32:35], s48 offen sc1
    s_add_u32 s48, s48, 8192
    buffer_load_dwordx4 v[84:87], v7, s[32:35], s48 offen sc1
    s_add_u32 s48, s48, 8192
    buffer_load_dwordx4 v[88:91], v7, s[32:35], s48 offen sc1
    s_add_u32 s48, s48, 8192
    buffer_load_dwordx4 v[92:95], v7, s[32:35], s48 offen sc1
    s_sleep 4
L_apoll_g0:
L_apoll:
    s_cbranch_execz L_apoll_g1
    s_mov_b32 s48, s54
    buffer_load_dwordx4 v[96:99], v7, s[32:35], s48 offen sc1
    s_add_u32 s48, s48, 8192
    buffer_load_dwordx4 v[100:103], v7, s[32:35], s48 offen sc1
    s_add_u32 s48, s48, 8192
    buffer_load_dwordx4 v[104:107], v7, s[32:35], s48 offen sc1
    s_add_u32 s48, s48, 8192
    buffer_load_dwordx4 v[108:111], v7, s[32:35], s48 offen sc1
    s_add_u32 s48, s48, 8192
    buffer_load_dwordx4 v[112:115], v7, s[32:35], s48 offen sc1
    s_add_u32 s48, s48, 8192
    buffer_load_dwordx4 v[116:119], v7, s[32:35], s48 offen sc1
    s_add_u32 s48, s48, 8192
    buffer_load_dwordx4 v[120:123], v7, s[32:35], s48 offen sc1
    s_add_u32 s48, s48, 8192
    buffer_load_dwordx4 v[124:127], v7, s[32:35], s48 offen sc1
L_apoll_g1:
    s_waitcnt vmcnt(15)
    v_xor_b32 v64, s86, v64
    s_waitcnt vmcnt(14)
    v_xor_b32 v68, s86, v68
    v_or_b32 v11, v64, v68
    v_pk_add_f32 v[40:41], v[64:65], v[68:69]
    v_pk_add_f32 v[42:43], v[66:67], v[70:71]
    s_waitcnt vmcnt(13)
    v_xor_b32 v72, s86, v72
    v_pk_add_f32 v[40:41], v[40:41], v[72:73]
    v_pk_add_f32 v[42:43], v[42:43], v[74:75]
    s_waitcnt vmcnt(12)
    v_xor_b32 v76, s86, v76
    v_or3_b32 v11, v11, v72, v76
    v_pk_add_f32 v[40:41], v[40:41], v[76:77]
    v_pk_add_f32 v[42:43], v[42:43], v[78:79]
    s_waitcnt vmcnt(11)
    v_xor_b32 v80, s86, v80
    v_pk_add_f32 v[40:41], v[40:41], v[80:81]
    v_pk_add_f32 v[42:43], v[42:43], v[82:83]
    s_waitcnt vmcnt(10)
    v_xor_b32 v84, s86, v84
    v_or3_b32 v11, v11, v80, v84
    v_pk_add_f32 v[40:41], v[40:41], v[84:85]
    v_pk_add_f32 v[42:43], v[42:43], v[86:87]
    s_waitcnt vmcnt(9)
    v_xor_b32 v88, s86, v88
    v_pk_add_f32 v[40:41], v[40:41], v[88:89]
    v_pk_add_f32 v[42:43], v[42:43], v[90:91]
    s_waitcnt vmcnt(8)
    v_xor_b32 v92, s86, v92
    v_or3_b32 v11, v11, v88, v92
    v_pk_add_f32 v[40:41], v[40:41], v[92:93]
    v_pk_add_f32 v[42:43], v[42:43], v[94:95]
    v_and_b32 v11, 0xff, v11
    v_cmp_ne_u32 vcc, 0, v11
    s_cbranch_execz L_rd_58
    s_cbranch_vccz L_adone
    s_mov_b32 s48, s54
    buffer_load_dwordx4 v[64:67], v7, s[32:35], s48 offen sc1
    s_add_u32 s48, s48, 8192
    buffer_load_dwordx4 v[68:71], v7, s[32:35], s48 offen sc1
    s_add_u32 s48, s48, 8192
    buffer_load_dwordx4 v[72:75], v7, s[32:35], s48 offen sc1
    s_add_u32 s48, s48, 8192
    buffer_load_dwordx4 v[76:79], v7, s[32:35], s48 offen sc1
    s_add_u32 s48, s48, 8192
    buffer_load_dwordx4 v[80:83], v7, s[32:35], s48 offen sc1
    s_add_u32 s48, s48, 8192
    buffer_load_dwordx4 v[84:87], v7, s[32:35], s48 offen sc1
    s_add_u32 s48, s48, 8192
    buffer_load_dwordx4 v[88:91], v7, s[32:35], s48 offen sc1
    s_add_u32 s48, s48, 8192
    buffer_load_dwordx4 v[92:95], v7, s[32:35], s48 offen sc1
L_rd_58:
    s_waitcnt vmcnt(15)
    v_xor_b32 v96, s86, v96
    s_waitcnt vmcnt(14)
    v_xor_b32 v100, s86, v100
    v_or_b32 v11, v96, v100
    v_pk_add_f32 v[40:41], v[96:97], v[100:101]
    v_pk_add_f32 v[42:43], v[98:99], v[102:103]
    s_waitcnt vmcnt(13)
    v_xor_b32 v104, s86, v104
    v_pk_add_f32 v[40:41], v[40:41], v[104:105]
    v_pk_add_f32 v[42:43], v[42:43], v[106:107]
    s_waitcnt vmcnt(12)
    v_xor_b32 v108, s86, v108
    v_or3_b32 v11, v11, v104, v108
    v_pk_add_f32 v[40:41], v[40:41], v[108:109]
    v_pk_add_f32 v[42:43], v[42:43], v[110:111]
    s_waitcnt vmcnt(11)
    v_xor_b32 v112, s86, v112
    v_pk_add_f32 v[40:41], v[40:41], v[112:113]
    v_pk_add_f32 v[42:43], v[42:43], v[114:115]
    s_waitcnt vmcnt(10)
    v_xor_b32 v116, s86, v116
    v_or3_b32 v11, v11, v112, v116
    v_pk_add_f32 v[40:41], v[40:41], v[116:117]
    v_pk_add_f32 v[42:43], v[42:43], v[118:119]
    s_waitcnt vmcnt(9)
    v_xor_b32 v120, s86, v120
    v_pk_add_f32 v[40:41], v[40:41], v[120:121]
    v_pk_add_f32 v[42:43], v[42:43], v[122:123]
    s_waitcnt vmcnt(8)
    v_xor_b32 v124, s86, v124
    v_or3_b32 v11, v11, v120, v124
    v_pk_add_f32 v[40:41], v[40:41], v[124:125]
    v_pk_add_f32 v[42:43], v[42:43], v[126:127]
    v_and_b32 v11, 0xff, v11
    v_cmp_ne_u32 vcc, 0, v11
    s_cbranch_vccz L_adone
    s_add_u32 s58, s58, 1
    s_cmp_lt_u32 s58, 2097152
    s_cbranch_scc1 L_apoll
L_adone:
    v_permlane16_swap_b32 v40, v41
    v_permlane16_swap_b32 v42, v43
    v_add_f32 v40, v40, v41
    v_add_f32 v42, v42, v43
    s_nop 1
    v_permlane32_swap_b32 v40, v42
    v_add_f32 v40, v40, v42
    s_nop 1
    v_add_f32_dpp v40, v40, v40 row_ror:8 row_mask:0xf bank_mask:0xf
    v_cvt_pk_bf16_f32 v40, v40, v40
    v_lshlrev_b32 v36, 16, v40
    v_add_f32 v36, v36, v28
    v_cvt_pk_bf16_f32 v36, v36, v36
    v_lshlrev_b32 v36, 16, v36
    v_add_f32 v36, v36, v32
    v_cvt_pk_bf16_f32 v36, v36, v36
    s_cbranch_execz L_red_live
    s_mov_b32 exec_lo, 0x00ff00ff
    s_mov_b32 exec_hi, 0x00ff00ff
    buffer_store_short v36, v9, s[40:43], s56 offen
    s_cmp_eq_u32 s88, 0
    s_cbranch_scc0 L_red_end
    s_mov_b64 exec, 1
    buffer_store_dword v57, v3, s[32:35], 0 offen
L_red_end:
L_end:
    s_endpgm
L_code_end:
.section .rodata,"a"
.p2align 6
.amdhsa_kernel parallel_sum__sliding_block_cached__dense_activation_relu__decode_kernel
.amdhsa_next_free_vgpr 232
.amdhsa_next_free_sgpr 96
.amdhsa_accum_offset 232
.amdhsa_group_segment_fixed_size 0
.amdhsa_kernarg_size 88
.amdhsa_user_sgpr_count 2
.amdhsa_user_sgpr_kernarg_segment_ptr 1
.amdhsa_system_sgpr_workgroup_id_x 1
.amdhsa_float_denorm_mode_32 3
.end_amdhsa_kernel
```
